```python
import torch

def _softmax(x, axis=-1):
    return torch.softmax(x, dim=axis)
def _gelu(x):
    return torch.nn.functional.gelu(x, approximate="tanh")
def _silu(x):
    return torch.nn.functional.silu(x)
def _sigmoid(x):
    return torch.sigmoid(x)
def _layernorm(x, axis=-1, eps=1e-5):
    m = x.mean(dim=axis, keepdim=True)
    v = x.var(dim=axis, keepdim=True, unbiased=False)
    return (x - m) / torch.sqrt(v + eps)
def _scatter_add(tgt, idx, src, axis=0):
    return tgt.clone().index_add_(axis, idx, src)
def _segment_sum(src, seg, n):
    out = torch.zeros((n,) + src.shape[1:], dtype=src.dtype)
    return out.index_add_(0, seg, src)
def _pad(x, pw):
    flat = tuple(v for pair in reversed(pw) for v in pair)
    return torch.nn.functional.pad(x, flat)

kernel_name = 'gather_scatter__cheap_equivariant_egnn__graph'

def setup_inputs():

    _w = (lambda a: (lambda t: t.to(torch.bfloat16) if t.is_floating_point() else t)(torch.as_tensor(a)))
    N, deg, D, De = 10000, 32, 128, max(4, 1)
    E = N * deg
    return {
        "h": _w((lambda *s: torch.randn(*s, dtype=torch.bfloat16) * 0.1)(N, D)),
        "pos": _w((lambda *s: torch.randn(*s, dtype=torch.bfloat16) * 0.8)(N, 3)),
        "e_attr": _w((lambda *s: torch.randn(*s, dtype=torch.bfloat16) * 0.8)(E, De)),
        "src": _w((lambda lo, hi, *s: torch.randint(lo, hi, s))(0, N, E).to(torch.int64)),
        "dst": _w((lambda lo, hi, *s: torch.randint(lo, hi, s))(0, N, E).to(torch.int64)),
        "w_e": _w(0.1 * (lambda *s: torch.randn(*s, dtype=torch.bfloat16) * 0.8)(2 * D + 1 + De, D)),
        "w_x": _w(0.1 * (lambda *s: torch.randn(*s, dtype=torch.bfloat16) * 0.1)(D, 1)),
        "w_h": _w(0.1 * (lambda *s: torch.randn(*s, dtype=torch.bfloat16) * 0.1)(2 * D, D)),
    }

def reference(h, pos, e_attr, src, dst, w_e, w_x, w_h):
    N, D = h.shape[0], h.shape[1]
    diff = pos[dst] - pos[src]
    dist2 = torch.sum(diff * diff, axis=-1, keepdims=True)
    e_in = torch.concatenate([h[dst], h[src], dist2, e_attr], axis=-1)
    m_ij = _silu(e_in @ w_e)
    coord_scale = m_ij @ w_x
    pos_new = pos + _segment_sum(diff * coord_scale, dst, N)
    m_i = _segment_sum(m_ij, dst, N)
    h_new = h + _silu(torch.concatenate([h, m_i], axis=-1) @ w_h)
    return h_new, pos_new
```

```asm
; @launch kernel=gather_scatter__cheap_equivariant_egnn__graph_kernel grid=(250,1,1) block=(512,1,1) lds=161536
.amdgcn_target "amdgcn-amd-amdhsa--gfx950"
.text
.globl gather_scatter__cheap_equivariant_egnn__graph_kernel
.p2align 8
.type gather_scatter__cheap_equivariant_egnn__graph_kernel,@function
gather_scatter__cheap_equivariant_egnn__graph_kernel:
    s_cmp_ge_u32 s2, 240
    s_cbranch_scc1 F_NOROLE
    s_load_dwordx16 s[16:31], s[0:1], 0
    s_load_dwordx2 s[34:35], s[0:1], 80
    s_load_dwordx2 s[96:97], s[0:1], 72
    v_lshlrev_b32 v3, 4, v0
    s_getpc_b64 s[6:7]
    global_load_dword v208, v3, s[6:7]
    v_lshrrev_b32 v1, 6, v0
    v_and_b32 v2, 63, v0
    v_readfirstlane_b32 s3, v1
    s_lshr_b32 s8, s2, 3
    s_getpc_b64 s[100:101]
X_PCS:
    s_add_u32 s100, s100, K2_TAB-X_PCS
    s_addc_u32 s101, s101, 0
    s_lshl_b32 s95, s3, 10
    s_add_u32 m0, s95, 128256
    v_lshlrev_b32 v214, 4, v0
    global_load_lds_dwordx4 v214, s[100:101]
    v_mov_b64 v[216:217], 0
    v_mov_b64 v[218:219], 0
    v_add_u32 v213, 136448, v214
    ds_write_b128 v213, v[216:219] offset:0
    ds_write_b128 v213, v[216:219] offset:8192
    ds_write_b128 v213, v[216:219] offset:16384
    s_and_b32 s8, s8, 7
    s_cmp_ge_u32 s2, 125
    s_cbranch_scc1 K1_GEMM
    v_mov_b64 v[92:93], 0
    v_mov_b64 v[94:95], 0
    ds_write_b128 v3, v[92:95] offset:0
    s_cmp_ge_u32 s3, 3
    s_cbranch_scc1 K1B_NOZ
    ds_write_b128 v3, v[92:95] offset:8192
K1B_NOZ:
    v_lshlrev_b32 v4, 2, v0
    v_lshlrev_b32 v5, 5, v0
    v_lshlrev_b32 v6, 3, v0
    v_lshlrev_b32 v7, 4, v2
    s_mul_i32 s4, s2, 10240
    s_add_u32 s5, s4, 8192
    s_lshl_b32 s6, s4, 1
    s_add_u32 s7, s6, 16384
    s_lshl_b32 s8, s8, 13
    s_lshl_b32 s9, s3, 10
    s_add_u32 s8, s8, s9
    s_add_u32 m0, s8, 11264
    s_waitcnt lgkmcnt(0)
    s_barrier
    s_mov_b32 s36, s24
    s_and_b32 s37, s25, 0xffff
    s_mov_b32 s38, 1280000
    s_mov_b32 s39, 0x00020000
    buffer_load_dwordx4 v[8:11], v3, s[36:39], s4 offen
    buffer_load_dword v12, v4, s[36:39], s5 offen
    s_mov_b32 s40, s22
    s_and_b32 s41, s23, 0xffff
    s_mov_b32 s42, 1280000
    s_mov_b32 s43, 0x00020000
    buffer_load_dwordx4 v[16:19], v3, s[40:43], s4 offen
    buffer_load_dword v20, v4, s[40:43], s5 offen
    s_mov_b32 s48, s18
    s_and_b32 s49, s19, 0xffff
    s_mov_b32 s50, 60000
    s_mov_b32 s51, 0x00020000
    buffer_load_dwordx4 v7, s[48:51], s8 offen lds
    s_add_u32 s8, s8, 8192
    s_and_b32 s8, s8, 0xffff
    s_add_u32 m0, s8, 11264
    s_nop 0
    buffer_load_dwordx4 v7, s[48:51], s8 offen lds
    s_add_u32 s8, s8, 8192
    s_and_b32 s8, s8, 0xffff
    s_add_u32 m0, s8, 11264
    s_nop 0
    buffer_load_dwordx4 v7, s[48:51], s8 offen lds
    s_add_u32 s8, s8, 8192
    s_and_b32 s8, s8, 0xffff
    s_add_u32 m0, s8, 11264
    s_nop 0
    s_mov_b32 s52, s34
    s_and_b32 s53, s35, 0xffff
    s_mov_b32 s54, 268435456
    s_mov_b32 s55, 0x00020000
    v_mov_b32 v46, 4
    v_mov_b32 v47, 11264
    v_mul_u32_u24 v105, 20, v0
    v_mul_u32_u24 v104, 10, v0
    v_add_u32 v104, 97280, v104
    s_add_u32 s9, s3, 1
    s_lshl_b32 s9, 0xff, s9
    s_and_b32 s9, s9, 0xff
    v_lshlrev_b32 v114, 2, v2
    s_lshl_b32 s10, s3, 2
    v_mov_b32 v116, s10
    v_lshlrev_b32 v210, 4, v0
    v_and_b32 v211, 48, v0
    v_and_b32 v210, 0x3f0, v210
    s_mov_b32 s56, s16
    s_and_b32 s57, s17, 0xffff
    s_mov_b32 s58, 2560000
    s_mov_b32 s59, 0x00020000
    s_mov_b32 s88, s18
    s_and_b32 s89, s19, 0xffff
    s_mov_b32 s90, 60000
    s_mov_b32 s91, 0x00020000
    s_and_b32 s95, s2, 7
    v_xor_b32 v211, v211, v210
    s_mul_i32 s94, s95, 31
    v_and_b32 v213, 7, v0
    s_min_u32 s95, s95, 2
    v_bfe_u32 v214, v0, 3, 3
    s_add_u32 s94, s94, s95
    v_mul_u32_u24 v213, 3, v213
    s_lshr_b32 s95, s2, 3
    v_min_u32 v214, 2, v214
    s_add_u32 s94, s94, s95
    v_add_lshl_u32 v213, v213, v214, 1
    s_mul_i32 s60, s94, 5
    s_add_u32 s60, s60, s3
    s_mul_i32 s60, s60, 48
    s_and_b32 s95, s3, 3
    s_lshl_b32 s95, s95, 6
    v_xor_b32 v211, s95, v211
    s_lshl_b32 s95, s3, 4
    v_xor_b32 v214, s95, v210
    s_mul_i32 s94, s94, 10240
    s_lshl_b32 s61, s3, 10
    s_lshl_b32 s62, s3, 8
    s_add_u32 s62, s62, 8192
    s_add_u32 s95, s94, s62
    s_add_u32 s94, s94, s61
    s_waitcnt vmcnt(5)
    v_and_b32 v34, 0xfffffffc, v8
    ds_add_rtn_u32 v40, v34, v46 offset:0
    v_and_b32 v35, 0xfffffffc, v9
    ds_add_rtn_u32 v41, v35, v46 offset:0
    v_and_b32 v36, 0xfffffffc, v10
    ds_add_rtn_u32 v42, v36, v46 offset:0
    v_and_b32 v37, 0xfffffffc, v11
    ds_add_rtn_u32 v43, v37, v46 offset:0
    v_and_b32 v38, 0xfffffffc, v12
    ds_add_rtn_u32 v44, v38, v46 offset:0
    s_mov_b32 s44, s20
    s_and_b32 s45, s21, 0xffff
    s_mov_b32 s46, 2560000
    s_mov_b32 s47, 0x00020000
    buffer_load_dwordx4 v[24:27], v5, s[44:47], s6 offen
    buffer_load_dwordx4 v[28:31], v5, s[44:47], s6 offen offset:16
    buffer_load_dwordx2 v[32:33], v6, s[44:47], s7 offen
    v_mov_b32 v100, 97280
    v_lshrrev_b32 v34, 1, v34
    v_add_u32 v34, v100, v34
    v_lshlrev_b32 v8, 30, v8
    v_lshrrev_b32 v35, 1, v35
    v_add_u32 v35, v100, v35
    v_lshlrev_b32 v9, 30, v9
    v_lshrrev_b32 v36, 1, v36
    v_add_u32 v36, v100, v36
    v_lshlrev_b32 v10, 30, v10
    v_lshrrev_b32 v37, 1, v37
    v_add_u32 v37, v100, v37
    v_lshlrev_b32 v11, 30, v11
    v_lshrrev_b32 v38, 1, v38
    v_add_u32 v38, v100, v38
    v_lshlrev_b32 v12, 30, v12
    s_waitcnt lgkmcnt(0)
    s_barrier
    ds_read2_b32 v[106:107], v105 offset0:0 offset1:1
    ds_read2_b32 v[108:109], v105 offset0:2 offset1:3
    ds_read_b32 v110, v105 offset:16
    buffer_load_dwordx4 v7, s[48:51], s8 offen lds
    s_add_u32 s8, s8, 8192
    s_and_b32 s8, s8, 0xffff
    s_add_u32 m0, s8, 11264
    s_nop 0
    buffer_load_dwordx4 v7, s[48:51], s8 offen lds
    s_add_u32 s8, s8, 8192
    s_and_b32 s8, s8, 0xffff
    s_add_u32 m0, s8, 11264
    s_nop 0
    buffer_load_dwordx4 v7, s[48:51], s8 offen lds
    s_add_u32 s8, s8, 8192
    s_and_b32 s8, s8, 0xffff
    s_add_u32 m0, s8, 11264
    s_nop 0
    s_waitcnt lgkmcnt(0)
    v_add_u32 v107, v106, v107
    v_add_u32 v108, v107, v108
    v_add_u32 v109, v108, v109
    v_add_u32 v110, v109, v110
    v_mov_b32 v113, v110
    s_nop 1
    v_add_u32_dpp v113, v113, v113 row_shr:1 row_mask:0xf bank_mask:0xf bound_ctrl:0
    s_nop 1
    v_add_u32_dpp v113, v113, v113 row_shr:2 row_mask:0xf bank_mask:0xf bound_ctrl:0
    s_nop 1
    v_add_u32_dpp v113, v113, v113 row_shr:4 row_mask:0xf bank_mask:0xf bound_ctrl:0
    s_nop 1
    v_add_u32_dpp v113, v113, v113 row_shr:8 row_mask:0xf bank_mask:0xf bound_ctrl:0
    s_nop 1
    v_add_u32_dpp v113, v113, v113 row_bcast:15 row_mask:0xa bank_mask:0xf
    s_nop 1
    v_add_u32_dpp v113, v113, v113 row_bcast:31 row_mask:0xc bank_mask:0xf
    s_nop 0
    v_readlane_b32 s11, v113, 63
    v_sub_u32 v113, v113, v110
    s_mov_b32 exec_lo, s9
    s_mov_b32 exec_hi, 0
    v_mov_b32 v115, s11
    ds_add_u32 v114, v115 offset:10240
    s_mov_b64 exec, -1
    s_waitcnt lgkmcnt(0)
    s_barrier
    ds_read_b32 v114, v116 offset:10240
    buffer_load_dwordx4 v7, s[48:51], s8 offen lds
    s_add_u32 s8, s8, 8192
    s_and_b32 s8, s8, 0xffff
    s_add_u32 m0, s8, 11264
    s_nop 0
    buffer_load_dwordx4 v7, s[48:51], s8 offen lds
    s_waitcnt lgkmcnt(0)
    v_add_u32 v113, v113, v114
    ds_write_b16 v104, v113
    v_add_u32 v106, v113, v106
    ds_write_b16 v104, v106 offset:2
    v_add_u32 v107, v113, v107
    ds_write_b16 v104, v107 offset:4
    v_add_u32 v108, v113, v108
    ds_write_b16 v104, v108 offset:6
    v_add_u32 v109, v113, v109
    ds_write_b16 v104, v109 offset:8
    v_mov_b32 v100, 76800
    s_mul_i32 s9, s2, 46080
    s_waitcnt lgkmcnt(0)
    s_barrier
    ds_read_u16 v90, v34
    ds_read_u16 v91, v35
    ds_read_u16 v92, v36
    ds_read_u16 v93, v37
    ds_read_u16 v94, v38
    s_waitcnt vmcnt(11)
    v_mad_u32_u24 v95, v16, 6, v47
    v_and_b32 v95, 0xfffffffc, v95
    v_lshlrev_b32 v120, 4, v16
    v_lshl_or_b32 v8, v16, 16, v8
    v_mad_u32_u24 v96, v17, 6, v47
    v_and_b32 v96, 0xfffffffc, v96
    v_lshlrev_b32 v121, 4, v17
    v_lshl_or_b32 v9, v17, 16, v9
    v_mad_u32_u24 v97, v18, 6, v47
    v_and_b32 v97, 0xfffffffc, v97
    v_lshlrev_b32 v122, 4, v18
    v_lshl_or_b32 v10, v18, 16, v10
    v_mad_u32_u24 v98, v19, 6, v47
    v_and_b32 v98, 0xfffffffc, v98
    v_lshlrev_b32 v123, 4, v19
    v_lshl_or_b32 v11, v19, 16, v11
    v_mad_u32_u24 v99, v20, 6, v47
    v_and_b32 v99, 0xfffffffc, v99
    v_lshlrev_b32 v124, 4, v20
    v_lshl_or_b32 v12, v20, 16, v12
    s_waitcnt lgkmcnt(4)
    v_add_u32 v90, v90, v40
    v_lshl_add_u32 v90, v90, 1, v100
    s_waitcnt vmcnt(7)
    ds_write_b64 v90, v[24:25]
    s_waitcnt lgkmcnt(4)
    v_add_u32 v91, v91, v41
    v_lshl_add_u32 v91, v91, 1, v100
    ds_write_b64 v91, v[26:27]
    s_waitcnt lgkmcnt(4)
    v_add_u32 v92, v92, v42
    v_lshl_add_u32 v92, v92, 1, v100
    s_waitcnt vmcnt(6)
    ds_write_b64 v92, v[28:29]
    s_waitcnt lgkmcnt(4)
    v_add_u32 v93, v93, v43
    v_lshl_add_u32 v93, v93, 1, v100
    ds_write_b64 v93, v[30:31]
    s_waitcnt lgkmcnt(4)
    v_add_u32 v94, v94, v44
    v_lshl_add_u32 v94, v94, 1, v100
    s_waitcnt vmcnt(5)
    ds_write_b64 v94, v[32:33]
    v_add_u32 v100, v100, v3
    s_mov_b32 m0, s61
    buffer_load_ushort v209, v213, s[88:91], s60 offen
    buffer_load_dwordx4 v211, s[56:59], s94 offen lds
    s_mov_b32 m0, s62
    s_mov_b64 exec, 0xffff
    buffer_load_dwordx4 v214, s[56:59], s95 offen lds
    s_mov_b64 exec, -1
    s_waitcnt vmcnt(3) lgkmcnt(0)
    s_barrier
    ds_read_b128 v[60:63], v100 offset:0
    ds_read_b128 v[64:67], v100 offset:8192
    ds_read_b128 v[68:71], v100 offset:16384
    ds_read2_b32 v[48:49], v95 offset0:0 offset1:1
    ds_read2_b32 v[50:51], v96 offset0:0 offset1:1
    ds_read2_b32 v[52:53], v97 offset0:0 offset1:1
    ds_read2_b32 v[54:55], v98 offset0:0 offset1:1
    ds_read2_b32 v[56:57], v99 offset0:0 offset1:1
    s_waitcnt lgkmcnt(5)
    buffer_store_dwordx4 v[60:63], v3, s[52:55], s9 offen sc1
    s_add_u32 s9, s9, 8192
    buffer_store_dwordx4 v[64:67], v3, s[52:55], s9 offen sc1
    s_add_u32 s9, s9, 8192
    buffer_store_dwordx4 v[68:71], v3, s[52:55], s9 offen sc1
    s_add_u32 s9, s9, 8192
    s_waitcnt lgkmcnt(4)
    v_alignbit_b32 v48, v49, v48, v120
    v_bfe_u32 v49, v49, v120, 16
    v_or_b32 v49, v49, v8
    ds_write_b64 v90, v[48:49] offset:25600
    s_waitcnt lgkmcnt(4)
    v_alignbit_b32 v50, v51, v50, v121
    v_bfe_u32 v51, v51, v121, 16
    v_or_b32 v51, v51, v9
    ds_write_b64 v91, v[50:51] offset:25600
    s_waitcnt lgkmcnt(4)
    v_alignbit_b32 v52, v53, v52, v122
    v_bfe_u32 v53, v53, v122, 16
    v_or_b32 v53, v53, v10
    ds_write_b64 v92, v[52:53] offset:25600
    s_waitcnt lgkmcnt(4)
    v_alignbit_b32 v54, v55, v54, v123
    v_bfe_u32 v55, v55, v123, 16
    v_or_b32 v55, v55, v11
    ds_write_b64 v93, v[54:55] offset:25600
    s_waitcnt lgkmcnt(4)
    v_alignbit_b32 v56, v57, v56, v124
    v_bfe_u32 v57, v57, v124, 16
    v_or_b32 v57, v57, v12
    ds_write_b64 v94, v[56:57] offset:25600
    s_waitcnt lgkmcnt(0) vmcnt(3)
    s_barrier
    ds_read_b128 v[20:23], v100 offset:24576
    ds_read_b128 v[24:27], v100 offset:32768
    s_cmp_ge_u32 s3, 5
    s_cbranch_scc1 K1B_NO8
    ds_read_b128 v[36:39], v100 offset:40960
    s_add_u32 s10, s9, 16384
    s_waitcnt lgkmcnt(0)
    buffer_store_dwordx4 v[36:39], v3, s[52:55], s10 offen sc1
K1B_NO8:
    s_waitcnt lgkmcnt(1)
    buffer_store_dwordx4 v[20:23], v3, s[52:55], s9 offen sc1
    s_add_u32 s9, s9, 8192
    s_waitcnt lgkmcnt(0)
    buffer_store_dwordx4 v[24:27], v3, s[52:55], s9 offen sc1
    s_branch K2_ENTRY
K1_GEMM:
    s_sub_u32 s4, s2, 125
    s_cmp_ge_u32 s4, 107
    s_cbranch_scc1 K1_PRE
    s_and_b32 s9, s2, 7
    s_mul_i32 s10, s9, 13
    s_cmp_gt_u32 s9, 5
    s_addc_u32 s10, s10, 0
    s_lshr_b32 s9, s4, 3
    s_add_u32 s10, s10, s9
    s_cmp_lt_u32 s4, 105
    s_cselect_b32 s4, s10, s4
    v_lshrrev_b32 v4, 4, v2
    v_and_b32 v5, 15, v2
    v_lshlrev_b32 v6, 2, v4
    v_xor_b32 v6, v6, v5
    v_lshlrev_b32 v6, 4, v6
    v_lshl_add_u32 v6, v4, 8, v6
    v_xor_b32 v7, v4, v5
    v_lshlrev_b32 v7, 4, v7
    v_lshl_add_u32 v7, v4, 8, v7
    s_and_b32 s8, s8, 3
    s_lshl_b32 s8, s8, 13
    s_lshl_b32 s9, s3, 10
    s_add_u32 s8, s8, s9
    s_mul_i32 s9, s3, 3
    s_mul_i32 s10, s4, 24576
    s_cmp_eq_u32 s4, 105
    s_cselect_b32 s5, 0, 32768
    s_waitcnt lgkmcnt(0)
    s_mov_b32 s40, s16
    s_and_b32 s41, s17, 0xffff
    s_mov_b32 s42, 2560000
    s_mov_b32 s43, 0x00020000
    s_and_b32 s11, s9, 3
    s_lshl_b32 s11, s11, 6
    v_xor_b32 v8, s11, v7
    s_lshl_b32 s11, s9, 10
    s_add_u32 m0, s11, 77824
    s_add_u32 s11, s11, s10
    buffer_load_dwordx4 v8, s[40:43], s11 offen lds
    s_add_u32 s9, s9, 1
    s_and_b32 s11, s9, 3
    s_lshl_b32 s11, s11, 6
    v_xor_b32 v8, s11, v7
    s_lshl_b32 s11, s9, 10
    s_add_u32 m0, s11, 77824
    s_add_u32 s11, s11, s10
    buffer_load_dwordx4 v8, s[40:43], s11 offen lds
    s_add_u32 s9, s9, 1
    s_and_b32 s11, s9, 3
    s_lshl_b32 s11, s11, 6
    v_xor_b32 v8, s11, v7
    s_lshl_b32 s11, s9, 10
    s_add_u32 m0, s11, 77824
    s_add_u32 s11, s11, s10
    buffer_load_dwordx4 v8, s[40:43], s11 offen lds
    s_cmp_ge_u32 s4, 105
    s_cselect_b32 s36, s30, s26
    s_cselect_b32 s37, s31, s27
    s_and_b32 s37, s37, 0xffff
    s_mov_b32 s38, 65536
    s_mov_b32 s39, 0x00020000
    s_lshl_b32 s11, s2, 10
    s_and_b32 s11, s11, 0xe000
    s_lshl_b32 s12, s3, 10
    s_add_u32 s11, s11, s12
    v_lshlrev_b32 v9, 7, v2
    s_mov_b64 exec, 0xff
    buffer_load_dword v208, v9, s[36:39], s11 offen
    s_mov_b64 exec, -1
    s_barrier
    s_add_u32 m0, s8, 12288
    s_add_u32 s11, s8, s5
    buffer_load_dwordx4 v6, s[36:39], s11 offen lds
    s_add_u32 s8, s8, 8192
    s_and_b32 s8, s8, 0x7fff
    s_add_u32 m0, s8, 12288
    s_add_u32 s11, s8, s5
    buffer_load_dwordx4 v6, s[36:39], s11 offen lds
    s_add_u32 s8, s8, 8192
    s_and_b32 s8, s8, 0x7fff
    s_add_u32 m0, s8, 12288
    s_add_u32 s11, s8, s5
    buffer_load_dwordx4 v6, s[36:39], s11 offen lds
    s_add_u32 s8, s8, 8192
    s_and_b32 s8, s8, 0x7fff
    s_add_u32 m0, s8, 12288
    s_add_u32 s11, s8, s5
    buffer_load_dwordx4 v6, s[36:39], s11 offen lds
    s_mov_b32 s52, s34
    s_and_b32 s53, s35, 0xffff
    s_mov_b32 s54, 268435456
    s_mov_b32 s55, 0x00020000
    s_and_b32 s12, s3, 3
    v_lshrrev_b32 v9, 2, v5
    v_and_b32 v10, 3, v5
    v_lshrrev_b32 v11, 5, v2
    v_and_b32 v12, 1, v4
    v_and_b32 v14, 31, v2
    s_mov_b32 s15, 0xbfb8aa3b
    s_mov_b32 s14, 0xbfb8aa3b
    s_cmp_ge_u32 s4, 105
    s_cbranch_scc1 K1_WHF
    v_xor_b32 v15, v11, v5
    v_lshlrev_b32 v15, 4, v15
    v_lshl_add_u32 v15, v14, 8, v15
    v_add_u32 v15, 77824, v15
    v_xor_b32 v16, 0, v15
    v_xor_b32 v17, 32, v15
    v_xor_b32 v18, 64, v15
    v_xor_b32 v19, 96, v15
    v_xor_b32 v20, 128, v15
    v_xor_b32 v21, 160, v15
    v_xor_b32 v22, 192, v15
    v_xor_b32 v23, 224, v15
    v_lshlrev_b32 v13, 5, v12
    v_lshl_add_u32 v13, v10, 3, v13
    s_cmp_lt_u32 s3, 4
    s_cbranch_scc1 K1G_B
    v_lshrrev_b32 v25, 2, v2
    v_lshlrev_b32 v25, 8, v25
    v_lshl_add_u32 v25, v10, 4, v25
    s_lshl_b32 s10, s12, 13
    s_add_u32 s10, s10, 45056
    v_lshl_add_u32 v13, v9, 6, v13
    v_lshl_add_u32 v13, v11, 9, v13
    v_add_u32 v13, s10, v13
    s_lshl_b32 s11, s12, 6
    v_lshlrev_b32 v24, 3, v2
    s_mul_i32 s9, s4, 24576
    s_lshl_b32 s13, s12, 9
    s_add_u32 s9, s9, s13
    s_add_u32 s9, s9, 8388608
    s_mov_b32 m0, s10
    s_add_u32 s10, s10, 1024
    buffer_load_dwordx4 v25, s[36:39], s11 offen lds
    s_add_u32 s11, s11, 4096
    s_mov_b32 m0, s10
    s_add_u32 s10, s10, 1024
    buffer_load_dwordx4 v25, s[36:39], s11 offen lds
    s_add_u32 s11, s11, 4096
    s_mov_b32 m0, s10
    s_add_u32 s10, s10, 1024
    buffer_load_dwordx4 v25, s[36:39], s11 offen lds
    s_add_u32 s11, s11, 4096
    s_mov_b32 m0, s10
    s_add_u32 s10, s10, 1024
    buffer_load_dwordx4 v25, s[36:39], s11 offen lds
    s_add_u32 s11, s11, 4096
    s_mov_b32 m0, s10
    s_add_u32 s10, s10, 1024
    buffer_load_dwordx4 v25, s[36:39], s11 offen lds
    s_add_u32 s11, s11, 4096
    s_mov_b32 m0, s10
    s_add_u32 s10, s10, 1024
    buffer_load_dwordx4 v25, s[36:39], s11 offen lds
    s_add_u32 s11, s11, 4096
    s_mov_b32 m0, s10
    s_add_u32 s10, s10, 1024
    buffer_load_dwordx4 v25, s[36:39], s11 offen lds
    s_add_u32 s11, s11, 4096
    s_mov_b32 m0, s10
    s_add_u32 s10, s10, 1024
    buffer_load_dwordx4 v25, s[36:39], s11 offen lds
    s_add_u32 s11, s11, 4096
    v_lshlrev_b32 v210, 4, v0
    v_and_b32 v211, 48, v0
    v_and_b32 v210, 0x3f0, v210
    s_mov_b32 s56, s16
    s_and_b32 s57, s17, 0xffff
    s_mov_b32 s58, 2560000
    s_mov_b32 s59, 0x00020000
    s_mov_b32 s88, s18
    s_and_b32 s89, s19, 0xffff
    s_mov_b32 s90, 60000
    s_mov_b32 s91, 0x00020000
    s_and_b32 s95, s2, 7
    v_xor_b32 v211, v211, v210
    s_mul_i32 s94, s95, 31
    v_and_b32 v213, 7, v0
    s_min_u32 s95, s95, 2
    v_bfe_u32 v214, v0, 3, 3
    s_add_u32 s94, s94, s95
    v_mul_u32_u24 v213, 3, v213
    s_lshr_b32 s95, s2, 3
    v_min_u32 v214, 2, v214
    s_add_u32 s94, s94, s95
    v_add_lshl_u32 v213, v213, v214, 1
    s_mul_i32 s60, s94, 5
    s_add_u32 s60, s60, s3
    s_mul_i32 s60, s60, 48
    s_and_b32 s95, s3, 3
    s_lshl_b32 s95, s95, 6
    v_xor_b32 v211, s95, v211
    s_lshl_b32 s95, s3, 4
    v_xor_b32 v214, s95, v210
    s_mul_i32 s94, s94, 10240
    s_lshl_b32 s61, s3, 10
    s_lshl_b32 s62, s3, 8
    s_add_u32 s62, s62, 8192
    s_add_u32 s95, s94, s62
    s_add_u32 s94, s94, s61
    s_waitcnt vmcnt(8)
    s_barrier
    ds_read_b128 v[64:67], v16 offset:0
    ds_read_b128 v[68:71], v17 offset:0
    ds_read_b128 v[72:75], v18 offset:0
    ds_read_b128 v[76:79], v19 offset:0
    ds_read_b128 v[80:83], v20 offset:0
    ds_read_b128 v[84:87], v21 offset:0
    ds_read_b128 v[88:91], v22 offset:0
    ds_read_b128 v[92:95], v23 offset:0
    ds_read_b128 v[96:99], v16 offset:8192
    ds_read_b128 v[100:103], v17 offset:8192
    ds_read_b128 v[104:107], v18 offset:8192
    ds_read_b128 v[108:111], v19 offset:8192
    ds_read_b128 v[112:115], v20 offset:8192
    ds_read_b128 v[116:119], v21 offset:8192
    ds_read_b128 v[120:123], v22 offset:8192
    ds_read_b128 v[124:127], v23 offset:8192
    ds_read_b128 v[128:131], v16 offset:16384
    ds_read_b128 v[132:135], v17 offset:16384
    ds_read_b128 v[136:139], v18 offset:16384
    ds_read_b128 v[140:143], v19 offset:16384
    ds_read_b128 v[144:147], v20 offset:16384
    ds_read_b128 v[148:151], v21 offset:16384
    ds_read_b128 v[152:155], v22 offset:16384
    ds_read_b128 v[156:159], v23 offset:16384
    s_waitcnt vmcnt(7)
    ds_read_b64_tr_b16 v[32:33], v13 offset:0
    ds_read_b64_tr_b16 v[34:35], v13 offset:256
    s_waitcnt vmcnt(6)
    ds_read_b64_tr_b16 v[36:37], v13 offset:1024
    ds_read_b64_tr_b16 v[38:39], v13 offset:1280
    s_waitcnt vmcnt(5)
    ds_read_b64_tr_b16 v[40:41], v13 offset:2048
    ds_read_b64_tr_b16 v[42:43], v13 offset:2304
    s_waitcnt vmcnt(4)
    ds_read_b64_tr_b16 v[44:45], v13 offset:3072
    ds_read_b64_tr_b16 v[46:47], v13 offset:3328
    s_waitcnt vmcnt(3)
    ds_read_b64_tr_b16 v[48:49], v13 offset:4096
    ds_read_b64_tr_b16 v[50:51], v13 offset:4352
    s_waitcnt vmcnt(2)
    ds_read_b64_tr_b16 v[52:53], v13 offset:5120
    ds_read_b64_tr_b16 v[54:55], v13 offset:5376
    s_waitcnt vmcnt(1)
    ds_read_b64_tr_b16 v[56:57], v13 offset:6144
    ds_read_b64_tr_b16 v[58:59], v13 offset:6400
    s_waitcnt vmcnt(0)
    ds_read_b64_tr_b16 v[60:61], v13 offset:7168
    ds_read_b64_tr_b16 v[62:63], v13 offset:7424
    s_mov_b32 m0, s61
    buffer_load_ushort v209, v213, s[88:91], s60 offen
    buffer_load_dwordx4 v211, s[56:59], s94 offen lds
    s_mov_b32 m0, s62
    s_mov_b64 exec, 0xffff
    buffer_load_dwordx4 v214, s[56:59], s95 offen lds
    s_mov_b64 exec, -1
    s_waitcnt lgkmcnt(14)
    v_mfma_f32_32x32x16_bf16 v[160:175], v[64:67], v[32:35], 0
    s_waitcnt lgkmcnt(12)
    v_mfma_f32_32x32x16_bf16 v[160:175], v[68:71], v[36:39], v[160:175]
    s_waitcnt lgkmcnt(10)
    v_mfma_f32_32x32x16_bf16 v[160:175], v[72:75], v[40:43], v[160:175]
    s_waitcnt lgkmcnt(8)
    v_mfma_f32_32x32x16_bf16 v[160:175], v[76:79], v[44:47], v[160:175]
    s_waitcnt lgkmcnt(6)
    v_mfma_f32_32x32x16_bf16 v[160:175], v[80:83], v[48:51], v[160:175]
    s_waitcnt lgkmcnt(4)
    v_mfma_f32_32x32x16_bf16 v[160:175], v[84:87], v[52:55], v[160:175]
    s_waitcnt lgkmcnt(2)
    v_mfma_f32_32x32x16_bf16 v[160:175], v[88:91], v[56:59], v[160:175]
    s_waitcnt lgkmcnt(0)
    v_mfma_f32_32x32x16_bf16 v[160:175], v[92:95], v[60:63], v[160:175]
    v_mfma_f32_32x32x16_bf16 v[176:191], v[96:99], v[32:35], 0
    v_mfma_f32_32x32x16_bf16 v[176:191], v[100:103], v[36:39], v[176:191]
    v_pk_mul_f32 v[160:161], v[160:161], s[14:15]
    v_pk_mul_f32 v[162:163], v[162:163], s[14:15]
    v_pk_mul_f32 v[164:165], v[164:165], s[14:15]
    v_pk_mul_f32 v[166:167], v[166:167], s[14:15]
    v_mfma_f32_32x32x16_bf16 v[176:191], v[104:107], v[40:43], v[176:191]
    v_pk_mul_f32 v[168:169], v[168:169], s[14:15]
    v_pk_mul_f32 v[170:171], v[170:171], s[14:15]
    v_pk_mul_f32 v[172:173], v[172:173], s[14:15]
    v_pk_mul_f32 v[174:175], v[174:175], s[14:15]
    v_mfma_f32_32x32x16_bf16 v[176:191], v[108:111], v[44:47], v[176:191]
    v_cvt_pk_bf16_f32 v64, v160, v161
    v_cvt_pk_bf16_f32 v65, v162, v163
    v_cvt_pk_bf16_f32 v66, v164, v165
    v_cvt_pk_bf16_f32 v67, v166, v167
    v_mfma_f32_32x32x16_bf16 v[176:191], v[112:115], v[48:51], v[176:191]
    v_cvt_pk_bf16_f32 v68, v168, v169
    v_cvt_pk_bf16_f32 v69, v170, v171
    v_cvt_pk_bf16_f32 v70, v172, v173
    v_cvt_pk_bf16_f32 v71, v174, v175
    v_mfma_f32_32x32x16_bf16 v[176:191], v[116:119], v[52:55], v[176:191]
    s_add_u32 s10, s9, 0
    buffer_store_dwordx2 v[64:65], v24, s[52:55], s10 offen offset:0 sc1
    buffer_store_dwordx2 v[66:67], v24, s[52:55], s10 offen offset:2048 sc1
    s_add_u32 s10, s9, 4096
    v_mfma_f32_32x32x16_bf16 v[176:191], v[120:123], v[56:59], v[176:191]
    buffer_store_dwordx2 v[68:69], v24, s[52:55], s10 offen offset:0 sc1
    buffer_store_dwordx2 v[70:71], v24, s[52:55], s10 offen offset:2048 sc1
    v_mfma_f32_32x32x16_bf16 v[176:191], v[124:127], v[60:63], v[176:191]
    v_mfma_f32_32x32x16_bf16 v[192:207], v[128:131], v[32:35], 0
    v_mfma_f32_32x32x16_bf16 v[192:207], v[132:135], v[36:39], v[192:207]
    v_pk_mul_f32 v[176:177], v[176:177], s[14:15]
    v_pk_mul_f32 v[178:179], v[178:179], s[14:15]
    v_pk_mul_f32 v[180:181], v[180:181], s[14:15]
    v_pk_mul_f32 v[182:183], v[182:183], s[14:15]
    v_mfma_f32_32x32x16_bf16 v[192:207], v[136:139], v[40:43], v[192:207]
    v_pk_mul_f32 v[184:185], v[184:185], s[14:15]
    v_pk_mul_f32 v[186:187], v[186:187], s[14:15]
    v_pk_mul_f32 v[188:189], v[188:189], s[14:15]
    v_pk_mul_f32 v[190:191], v[190:191], s[14:15]
    v_mfma_f32_32x32x16_bf16 v[192:207], v[140:143], v[44:47], v[192:207]
    v_cvt_pk_bf16_f32 v72, v176, v177
    v_cvt_pk_bf16_f32 v73, v178, v179
    v_cvt_pk_bf16_f32 v74, v180, v181
    v_cvt_pk_bf16_f32 v75, v182, v183
    v_mfma_f32_32x32x16_bf16 v[192:207], v[144:147], v[48:51], v[192:207]
    v_cvt_pk_bf16_f32 v76, v184, v185
    v_cvt_pk_bf16_f32 v77, v186, v187
    v_cvt_pk_bf16_f32 v78, v188, v189
    v_cvt_pk_bf16_f32 v79, v190, v191
    v_mfma_f32_32x32x16_bf16 v[192:207], v[148:151], v[52:55], v[192:207]
    s_add_u32 s10, s9, 8192
    buffer_store_dwordx2 v[72:73], v24, s[52:55], s10 offen offset:0 sc1
    buffer_store_dwordx2 v[74:75], v24, s[52:55], s10 offen offset:2048 sc1
    s_add_u32 s10, s9, 12288
    v_mfma_f32_32x32x16_bf16 v[192:207], v[152:155], v[56:59], v[192:207]
    buffer_store_dwordx2 v[76:77], v24, s[52:55], s10 offen offset:0 sc1
    buffer_store_dwordx2 v[78:79], v24, s[52:55], s10 offen offset:2048 sc1
    v_mfma_f32_32x32x16_bf16 v[192:207], v[156:159], v[60:63], v[192:207]
    s_nop 7
    s_nop 3
    v_pk_mul_f32 v[192:193], v[192:193], s[14:15]
    v_pk_mul_f32 v[194:195], v[194:195], s[14:15]
    v_pk_mul_f32 v[196:197], v[196:197], s[14:15]
    v_pk_mul_f32 v[198:199], v[198:199], s[14:15]
    v_pk_mul_f32 v[200:201], v[200:201], s[14:15]
    v_pk_mul_f32 v[202:203], v[202:203], s[14:15]
    v_pk_mul_f32 v[204:205], v[204:205], s[14:15]
    v_pk_mul_f32 v[206:207], v[206:207], s[14:15]
    v_cvt_pk_bf16_f32 v80, v192, v193
    v_cvt_pk_bf16_f32 v81, v194, v195
    v_cvt_pk_bf16_f32 v82, v196, v197
    v_cvt_pk_bf16_f32 v83, v198, v199
    v_cvt_pk_bf16_f32 v84, v200, v201
    v_cvt_pk_bf16_f32 v85, v202, v203
    v_cvt_pk_bf16_f32 v86, v204, v205
    v_cvt_pk_bf16_f32 v87, v206, v207
    s_add_u32 s10, s9, 16384
    buffer_store_dwordx2 v[80:81], v24, s[52:55], s10 offen offset:0 sc1
    buffer_store_dwordx2 v[82:83], v24, s[52:55], s10 offen offset:2048 sc1
    s_add_u32 s10, s9, 20480
    buffer_store_dwordx2 v[84:85], v24, s[52:55], s10 offen offset:0 sc1
    buffer_store_dwordx2 v[86:87], v24, s[52:55], s10 offen offset:2048 sc1
    s_waitcnt vmcnt(12)
    s_barrier
    s_branch K2_ENTRY
K1G_B:
    v_lshl_add_u32 v13, v9, 8, v13
    v_xor_b32 v24, s12, v9
    v_lshl_add_u32 v13, v24, 6, v13
    v_lshl_add_u32 v13, v11, 11, v13
    v_bfe_u32 v24, v14, 2, 2
    v_lshlrev_b32 v26, 1, v11
    v_xor_b32 v24, v24, v26
    v_lshlrev_b32 v24, 4, v24
    v_lshl_add_u32 v24, v14, 6, v24
    s_mul_i32 s10, s12, 6144
    s_add_u32 s10, s10, 102400
    v_add_u32 v24, s10, v24
    v_xor_b32 v26, 16, v24
    v_lshlrev_b32 v27, 4, v2
    v_add_u32 v27, s10, v27
    v_and_b32 v28, 3, v2
    v_xor_b32 v28, v28, v4
    v_lshlrev_b32 v28, 4, v28
    v_lshrrev_b32 v29, 2, v2
    v_lshl_add_u32 v28, v29, 8, v28
    s_mul_i32 s9, s4, 24576
    s_lshl_b32 s10, s12, 6
    s_add_u32 s9, s9, s10
    s_add_u32 s9, s9, 5767168
    v_lshlrev_b32 v210, 4, v0
    v_and_b32 v211, 48, v0
    v_and_b32 v210, 0x3f0, v210
    s_mov_b32 s56, s16
    s_and_b32 s57, s17, 0xffff
    s_mov_b32 s58, 2560000
    s_mov_b32 s59, 0x00020000
    s_mov_b32 s88, s18
    s_and_b32 s89, s19, 0xffff
    s_mov_b32 s90, 60000
    s_mov_b32 s91, 0x00020000
    s_and_b32 s95, s2, 7
    v_xor_b32 v211, v211, v210
    s_mul_i32 s94, s95, 31
    v_and_b32 v213, 7, v0
    s_min_u32 s95, s95, 2
    v_bfe_u32 v214, v0, 3, 3
    s_add_u32 s94, s94, s95
    v_mul_u32_u24 v213, 3, v213
    s_lshr_b32 s95, s2, 3
    v_min_u32 v214, 2, v214
    s_add_u32 s94, s94, s95
    v_add_lshl_u32 v213, v213, v214, 1
    s_mul_i32 s60, s94, 5
    s_add_u32 s60, s60, s3
    s_mul_i32 s60, s60, 48
    s_and_b32 s95, s3, 3
    s_lshl_b32 s95, s95, 6
    v_xor_b32 v211, s95, v211
    s_lshl_b32 s95, s3, 4
    v_xor_b32 v214, s95, v210
    s_mul_i32 s94, s94, 10240
    s_lshl_b32 s61, s3, 10
    s_lshl_b32 s62, s3, 8
    s_add_u32 s62, s62, 8192
    s_add_u32 s95, s94, s62
    s_add_u32 s94, s94, s61
    s_waitcnt vmcnt(0)
    s_barrier
    ds_read_b64_tr_b16 v[32:33], v13 offset:12288
    ds_read_b64_tr_b16 v[34:35], v13 offset:13312
    ds_read_b128 v[64:67], v16
    ds_read_b64_tr_b16 v[36:37], v13 offset:16384
    ds_read_b64_tr_b16 v[38:39], v13 offset:17408
    ds_read_b128 v[68:71], v17
    ds_read_b64_tr_b16 v[40:41], v13 offset:20480
    ds_read_b64_tr_b16 v[42:43], v13 offset:21504
    ds_read_b128 v[72:75], v18
    ds_read_b64_tr_b16 v[44:45], v13 offset:24576
    ds_read_b64_tr_b16 v[46:47], v13 offset:25600
    ds_read_b128 v[76:79], v19
    ds_read_b64_tr_b16 v[48:49], v13 offset:28672
    ds_read_b64_tr_b16 v[50:51], v13 offset:29696
    ds_read_b128 v[80:83], v20
    ds_read_b64_tr_b16 v[52:53], v13 offset:32768
    ds_read_b64_tr_b16 v[54:55], v13 offset:33792
    ds_read_b128 v[84:87], v21
    ds_read_b64_tr_b16 v[56:57], v13 offset:36864
    ds_read_b64_tr_b16 v[58:59], v13 offset:37888
    ds_read_b128 v[88:91], v22
    ds_read_b64_tr_b16 v[60:61], v13 offset:40960
    ds_read_b64_tr_b16 v[62:63], v13 offset:41984
    ds_read_b128 v[92:95], v23
    s_mov_b32 m0, s61
    buffer_load_ushort v209, v213, s[88:91], s60 offen
    buffer_load_dwordx4 v211, s[56:59], s94 offen lds
    s_mov_b32 m0, s62
    s_mov_b64 exec, 0xffff
    buffer_load_dwordx4 v214, s[56:59], s95 offen lds
    s_mov_b64 exec, -1
    s_waitcnt lgkmcnt(15)
    v_mfma_f32_32x32x16_bf16 v[160:175], v[32:35], v[64:67], 0
    ds_read_b128 v[96:99], v16 offset:8192
    s_waitcnt lgkmcnt(15)
    v_mfma_f32_32x32x16_bf16 v[160:175], v[36:39], v[68:71], v[160:175]
    ds_read_b128 v[100:103], v17 offset:8192
    s_waitcnt lgkmcnt(15)
    v_mfma_f32_32x32x16_bf16 v[160:175], v[40:43], v[72:75], v[160:175]
    ds_read_b128 v[104:107], v18 offset:8192
    s_waitcnt lgkmcnt(15)
    v_mfma_f32_32x32x16_bf16 v[160:175], v[44:47], v[76:79], v[160:175]
    ds_read_b128 v[108:111], v19 offset:8192
    s_waitcnt lgkmcnt(13)
    v_mfma_f32_32x32x16_bf16 v[160:175], v[48:51], v[80:83], v[160:175]
    ds_read_b128 v[112:115], v20 offset:8192
    s_waitcnt lgkmcnt(11)
    v_mfma_f32_32x32x16_bf16 v[160:175], v[52:55], v[84:87], v[160:175]
    ds_read_b128 v[116:119], v21 offset:8192
    s_waitcnt lgkmcnt(9)
    v_mfma_f32_32x32x16_bf16 v[160:175], v[56:59], v[88:91], v[160:175]
    ds_read_b128 v[120:123], v22 offset:8192
    s_waitcnt lgkmcnt(7)
    v_mfma_f32_32x32x16_bf16 v[160:175], v[60:63], v[92:95], v[160:175]
    ds_read_b128 v[124:127], v23 offset:8192
    ds_read_b128 v[128:131], v16 offset:16384
    ds_read_b128 v[132:135], v17 offset:16384
    ds_read_b128 v[136:139], v18 offset:16384
    ds_read_b128 v[140:143], v19 offset:16384
    ds_read_b128 v[144:147], v20 offset:16384
    ds_read_b128 v[148:151], v21 offset:16384
    ds_read_b128 v[152:155], v22 offset:16384
    ds_read_b128 v[156:159], v23 offset:16384
    s_waitcnt lgkmcnt(8)
    v_mfma_f32_32x32x16_bf16 v[176:191], v[32:35], v[96:99], 0
    v_mfma_f32_32x32x16_bf16 v[176:191], v[36:39], v[100:103], v[176:191]
    v_pk_mul_f32 v[160:161], v[160:161], s[14:15]
    v_pk_mul_f32 v[162:163], v[162:163], s[14:15]
    v_pk_mul_f32 v[164:165], v[164:165], s[14:15]
    v_pk_mul_f32 v[166:167], v[166:167], s[14:15]
    v_mfma_f32_32x32x16_bf16 v[176:191], v[40:43], v[104:107], v[176:191]
    v_pk_mul_f32 v[168:169], v[168:169], s[14:15]
    v_pk_mul_f32 v[170:171], v[170:171], s[14:15]
    v_pk_mul_f32 v[172:173], v[172:173], s[14:15]
    v_pk_mul_f32 v[174:175], v[174:175], s[14:15]
    v_mfma_f32_32x32x16_bf16 v[176:191], v[44:47], v[108:111], v[176:191]
    v_cvt_pk_bf16_f32 v64, v160, v161
    v_cvt_pk_bf16_f32 v65, v162, v163
    v_cvt_pk_bf16_f32 v66, v164, v165
    v_cvt_pk_bf16_f32 v67, v166, v167
    v_mfma_f32_32x32x16_bf16 v[176:191], v[48:51], v[112:115], v[176:191]
    v_cvt_pk_bf16_f32 v68, v168, v169
    v_cvt_pk_bf16_f32 v69, v170, v171
    v_cvt_pk_bf16_f32 v70, v172, v173
    v_cvt_pk_bf16_f32 v71, v174, v175
    v_mfma_f32_32x32x16_bf16 v[176:191], v[52:55], v[116:119], v[176:191]
    ds_write_b128 v24, v[64:67] offset:0
    ds_write_b128 v26, v[68:71] offset:0
    ds_read_b128 v[160:163], v27 offset:0
    ds_read_b128 v[164:167], v27 offset:1024
    v_mfma_f32_32x32x16_bf16 v[176:191], v[56:59], v[120:123], v[176:191]
    v_mfma_f32_32x32x16_bf16 v[176:191], v[60:63], v[124:127], v[176:191]
    s_waitcnt lgkmcnt(4)
    v_mfma_f32_32x32x16_bf16 v[192:207], v[32:35], v[128:131], 0
    v_mfma_f32_32x32x16_bf16 v[192:207], v[36:39], v[132:135], v[192:207]
    s_waitcnt lgkmcnt(0)
    buffer_store_dwordx4 v[160:163], v28, s[52:55], s9 offen sc1
    s_add_u32 s9, s9, 4096
    buffer_store_dwordx4 v[164:167], v28, s[52:55], s9 offen sc1
    s_add_u32 s9, s9, 4096
    v_mfma_f32_32x32x16_bf16 v[192:207], v[40:43], v[136:139], v[192:207]
    v_pk_mul_f32 v[176:177], v[176:177], s[14:15]
    v_pk_mul_f32 v[178:179], v[178:179], s[14:15]
    v_pk_mul_f32 v[180:181], v[180:181], s[14:15]
    v_pk_mul_f32 v[182:183], v[182:183], s[14:15]
    v_pk_mul_f32 v[184:185], v[184:185], s[14:15]
    v_mfma_f32_32x32x16_bf16 v[192:207], v[44:47], v[140:143], v[192:207]
    v_pk_mul_f32 v[186:187], v[186:187], s[14:15]
    v_pk_mul_f32 v[188:189], v[188:189], s[14:15]
    v_pk_mul_f32 v[190:191], v[190:191], s[14:15]
    v_cvt_pk_bf16_f32 v72, v176, v177
    v_cvt_pk_bf16_f32 v73, v178, v179
    v_mfma_f32_32x32x16_bf16 v[192:207], v[48:51], v[144:147], v[192:207]
    v_cvt_pk_bf16_f32 v74, v180, v181
    v_cvt_pk_bf16_f32 v75, v182, v183
    v_cvt_pk_bf16_f32 v76, v184, v185
    v_cvt_pk_bf16_f32 v77, v186, v187
    v_cvt_pk_bf16_f32 v78, v188, v189
    v_mfma_f32_32x32x16_bf16 v[192:207], v[52:55], v[148:151], v[192:207]
    v_cvt_pk_bf16_f32 v79, v190, v191
    ds_write_b128 v24, v[72:75] offset:2048
    ds_write_b128 v26, v[76:79] offset:2048
    ds_read_b128 v[176:179], v27 offset:2048
    ds_read_b128 v[180:183], v27 offset:3072
    v_mfma_f32_32x32x16_bf16 v[192:207], v[56:59], v[152:155], v[192:207]
    v_mfma_f32_32x32x16_bf16 v[192:207], v[60:63], v[156:159], v[192:207]
    s_waitcnt lgkmcnt(0)
    buffer_store_dwordx4 v[176:179], v28, s[52:55], s9 offen sc1
    s_add_u32 s9, s9, 4096
    buffer_store_dwordx4 v[180:183], v28, s[52:55], s9 offen sc1
    s_add_u32 s9, s9, 4096
    s_nop 7
    s_waitcnt vmcnt(4)
    s_barrier
    v_pk_mul_f32 v[192:193], v[192:193], s[14:15]
    v_pk_mul_f32 v[194:195], v[194:195], s[14:15]
    v_pk_mul_f32 v[196:197], v[196:197], s[14:15]
    v_pk_mul_f32 v[198:199], v[198:199], s[14:15]
    v_pk_mul_f32 v[200:201], v[200:201], s[14:15]
    v_pk_mul_f32 v[202:203], v[202:203], s[14:15]
    v_pk_mul_f32 v[204:205], v[204:205], s[14:15]
    v_pk_mul_f32 v[206:207], v[206:207], s[14:15]
    v_cvt_pk_bf16_f32 v80, v192, v193
    v_cvt_pk_bf16_f32 v81, v194, v195
    v_cvt_pk_bf16_f32 v82, v196, v197
    v_cvt_pk_bf16_f32 v83, v198, v199
    v_cvt_pk_bf16_f32 v84, v200, v201
    v_cvt_pk_bf16_f32 v85, v202, v203
    v_cvt_pk_bf16_f32 v86, v204, v205
    v_cvt_pk_bf16_f32 v87, v206, v207
    ds_write_b128 v24, v[80:83] offset:4096
    ds_write_b128 v26, v[84:87] offset:4096
    ds_read_b128 v[192:195], v27 offset:4096
    ds_read_b128 v[196:199], v27 offset:5120
    s_waitcnt lgkmcnt(0)
    buffer_store_dwordx4 v[192:195], v28, s[52:55], s9 offen sc1
    s_add_u32 s9, s9, 4096
    buffer_store_dwordx4 v[196:199], v28, s[52:55], s9 offen sc1
    s_add_u32 s9, s9, 4096
    s_branch K2_ENTRY
K1_WHF:
    v_lshlrev_b32 v210, 4, v0
    v_and_b32 v211, 48, v0
    v_and_b32 v210, 0x3f0, v210
    s_mov_b32 s56, s16
    s_and_b32 s57, s17, 0xffff
    s_mov_b32 s58, 2560000
    s_mov_b32 s59, 0x00020000
    s_mov_b32 s88, s18
    s_and_b32 s89, s19, 0xffff
    s_mov_b32 s90, 60000
    s_mov_b32 s91, 0x00020000
    s_and_b32 s95, s2, 7
    v_xor_b32 v211, v211, v210
    s_mul_i32 s94, s95, 31
    v_and_b32 v213, 7, v0
    s_min_u32 s95, s95, 2
    v_bfe_u32 v214, v0, 3, 3
    s_add_u32 s94, s94, s95
    v_mul_u32_u24 v213, 3, v213
    s_lshr_b32 s95, s2, 3
    v_min_u32 v214, 2, v214
    s_add_u32 s94, s94, s95
    v_add_lshl_u32 v213, v213, v214, 1
    s_mul_i32 s60, s94, 5
    s_add_u32 s60, s60, s3
    s_mul_i32 s60, s60, 48
    s_and_b32 s95, s3, 3
    s_lshl_b32 s95, s95, 6
    v_xor_b32 v211, s95, v211
    s_lshl_b32 s95, s3, 4
    v_xor_b32 v214, s95, v210
    s_mul_i32 s94, s94, 10240
    s_lshl_b32 s61, s3, 10
    s_lshl_b32 s62, s3, 8
    s_add_u32 s62, s62, 8192
    s_add_u32 s95, s94, s62
    s_add_u32 s94, s94, s61
    s_mov_b32 m0, s61
    buffer_load_ushort v209, v213, s[88:91], s60 offen
    buffer_load_dwordx4 v211, s[56:59], s94 offen lds
    s_mov_b32 m0, s62
    s_mov_b64 exec, 0xffff
    buffer_load_dwordx4 v214, s[56:59], s95 offen lds
    s_mov_b64 exec, -1
    v_lshlrev_b32 v26, 4, v2
    s_lshl_b32 s9, s3, 1
    v_lshrrev_b32 v27, 1, v10
    v_add_u32 v27, s9, v27
    v_lshlrev_b32 v25, 2, v9
    v_xor_b32 v27, v27, v25
    v_lshlrev_b32 v27, 4, v27
    v_and_b32 v25, 1, v10
    v_lshl_add_u32 v27, v25, 3, v27
    v_lshl_add_u32 v27, v9, 8, v27
    s_lshl_b32 s13, s3, 13
    s_add_u32 s13, s13, 11010048
    s_cmp_eq_u32 s4, 105
    s_cbranch_scc1 K1_WHH
    v_lshl_add_u32 v27, v12, 12, v27
    v_lshl_add_u32 v27, v11, 10, v27
    s_add_u32 s13, s13, 4096
    s_waitcnt vmcnt(0)
    s_barrier
    ds_read_b64_tr_b16 v[32:33], v27 offset:12288
    ds_read_b64_tr_b16 v[34:35], v27 offset:14336
    ds_read_b64_tr_b16 v[36:37], v27 offset:20480
    ds_read_b64_tr_b16 v[38:39], v27 offset:22528
    ds_read_b64_tr_b16 v[40:41], v27 offset:28672
    ds_read_b64_tr_b16 v[42:43], v27 offset:30720
    ds_read_b64_tr_b16 v[44:45], v27 offset:36864
    ds_read_b64_tr_b16 v[46:47], v27 offset:38912
    s_branch K1_WHS
K1_WHH:
    s_mov_b32 s48, s26
    s_and_b32 s49, s27, 0xffff
    s_mov_b32 s50, 66816
    s_mov_b32 s51, 0x00020000
    v_sub_u32 v24, 1, v11
    v_lshlrev_b32 v24, 8, v24
    v_lshl_add_u32 v24, v14, 1, v24
    s_lshl_b32 s9, s12, 6
    s_add_u32 s10, s9, 65536
    buffer_load_ushort v70, v24, s[48:51], s10 offen offset:0
    buffer_load_ushort v71, v24, s[48:51], s10 offen offset:256
    buffer_load_ushort v72, v24, s[48:51], s10 offen offset:512
    buffer_load_ushort v73, v24, s[48:51], s10 offen offset:768
    s_mov_b32 s44, s28
    s_and_b32 s45, s29, 0xffff
    s_mov_b32 s46, 256
    s_mov_b32 s47, 0x00020000
    v_lshlrev_b32 v25, 3, v11
    buffer_load_dwordx2 v[76:77], v25, s[44:47], s9 offen offset:0
    buffer_load_dwordx2 v[78:79], v25, s[44:47], s9 offen offset:16
    buffer_load_dwordx2 v[80:81], v25, s[44:47], s9 offen offset:32
    buffer_load_dwordx2 v[82:83], v25, s[44:47], s9 offen offset:48
    v_lshl_add_u32 v27, v4, 11, v27
    s_waitcnt vmcnt(0)
    s_barrier
    v_mov_b32 v74, v70
    v_lshlrev_b32 v70, 16, v70
    v_mul_f32 v70, s15, v70
    v_lshlrev_b32 v71, 16, v71
    v_mul_f32 v71, s15, v71
    v_lshlrev_b32 v72, 16, v72
    v_mul_f32 v72, s15, v72
    v_lshlrev_b32 v73, 16, v73
    v_mul_f32 v73, s15, v73
    v_cvt_pk_bf16_f32 v84, v70, v71
    v_cvt_pk_bf16_f32 v85, v72, v73
    s_mov_b32 exec_lo, 0
    v_mov_b32 v84, v74
    v_mov_b32 v85, 0
    s_mov_b32 exec_lo, 0x0f0ff0f0
    s_mov_b32 exec_hi, 0x0f0ff0f0
    v_mov_b64 v[76:77], 0
    v_mov_b64 v[78:79], 0
    v_mov_b64 v[80:81], 0
    v_mov_b64 v[82:83], 0
    s_mov_b64 exec, -1
    s_mul_i32 s9, s12, 3072
    s_add_u32 s9, s9, 11075584
    v_mov_b64 v[86:87], 0
    s_cmp_ge_u32 s3, 4
    s_cbranch_scc1 K1_WHE
    buffer_store_dwordx4 v[76:79], v26, s[52:55], s9 offen sc1
    buffer_store_dwordx4 v[80:83], v26, s[52:55], s9 offen offset:1024 sc1
    buffer_store_dwordx4 v[84:87], v26, s[52:55], s9 offen offset:2048 sc1
    s_branch K1_WHE
K1_WHS:
    s_waitcnt lgkmcnt(0)
    s_barrier
    buffer_store_dwordx4 v[32:35], v26, s[52:55], s13 offen offset:0 sc1
    buffer_store_dwordx4 v[36:39], v26, s[52:55], s13 offen offset:1024 sc1
    buffer_store_dwordx4 v[40:43], v26, s[52:55], s13 offen offset:2048 sc1
    buffer_store_dwordx4 v[44:47], v26, s[52:55], s13 offen offset:3072 sc1
K1_WHE:
    s_branch K2_ENTRY
K1_PRE:
    s_getpc_b64 s[4:5]
K1_PC:
    s_add_u32 s4, s4, K2_ENTRY-K1_PC
    s_addc_u32 s5, s5, 0
    global_load_dwordx4 v[8:11], v3, s[4:5]
    v_add_u32 v3, 8192, v3
    v_min_u32 v4, K2_LAST-K2_ENTRY-16, v3
    global_load_dwordx4 v[12:15], v4, s[4:5]
    v_add_u32 v3, 8192, v3
    v_min_u32 v4, K2_LAST-K2_ENTRY-16, v3
    global_load_dwordx4 v[16:19], v4, s[4:5]
    v_lshlrev_b32 v4, 6, v0
    s_waitcnt lgkmcnt(0)
    global_load_dword v20, v4, s[30:31]
    s_waitcnt vmcnt(0)
    s_branch F_WAIT
F_NOROLE:
    s_cmp_ge_u32 s2, 250
    s_cbranch_scc1 K2_END
    s_cmp_lg_u32 s2, 240
    s_cbranch_scc1 F_WAIT
    s_load_dwordx4 s[96:99], s[0:1], 72
    v_readfirstlane_b32 s3, v0
    v_min_u32 v1, 7, v0
    v_mul_u32_u24 v1, 256, v1
    v_add_u32 v1, 11108352, v1
    v_mov_b64 v[4:5], 0
    v_mov_b64 v[6:7], 0
    v_lshrrev_b32 v2, 2, v0
    v_and_b32 v3, 3, v0
    v_lshlrev_b32 v2, 8, v2
    v_lshl_add_u32 v2, v3, 4, v2
    v_add_u32 v2, 11116544, v2
    v_mov_b32 v3, 1
    s_cmp_lg_u32 s3, 0
    s_waitcnt lgkmcnt(0)
    s_cbranch_scc1 F_WAIT
    global_load_dword v8, v4, s[96:97] offset:128
    global_store_dword v1, v4, s[98:99] sc1
    global_store_dwordx4 v2, v[4:7], s[98:99] sc1
    s_waitcnt vmcnt(0)
    s_mov_b64 exec, 1
    global_store_byte v4, v3, s[96:97] sc1
    s_mov_b64 exec, -1
F_WAIT:
    s_load_dwordx2 s[96:97], s[0:1], 72
    s_cmp_lt_u32 s2, 232
    s_cselect_b32 s98, 1, 0
    s_load_dwordx16 s[4:19], s[0:1], 0
    v_readfirstlane_b32 s3, v0
    v_mov_b32 v1, 0
    s_lshr_b32 s3, s3, 6
    s_waitcnt lgkmcnt(0)
    v_lshlrev_b32 v210, 4, v0
    v_and_b32 v211, 48, v0
    v_and_b32 v210, 0x3f0, v210
    s_getpc_b64 s[100:101]
X_PCN:
    s_add_u32 s100, s100, K2_TAB-X_PCN
    s_addc_u32 s101, s101, 0
    s_lshl_b32 s95, s3, 10
    s_add_u32 m0, s95, 128256
    v_lshlrev_b32 v214, 4, v0
    global_load_lds_dwordx4 v214, s[100:101]
    v_mov_b64 v[216:217], 0
    v_mov_b64 v[218:219], 0
    v_add_u32 v213, 136448, v214
    ds_write_b128 v213, v[216:219] offset:0
    ds_write_b128 v213, v[216:219] offset:8192
    ds_write_b128 v213, v[216:219] offset:16384
    s_mov_b32 s56, s4
    s_and_b32 s57, s5, 0xffff
    s_mov_b32 s58, 2560000
    s_mov_b32 s59, 0x00020000
    s_mov_b32 s88, s6
    s_and_b32 s89, s7, 0xffff
    s_mov_b32 s90, 60000
    s_mov_b32 s91, 0x00020000
    s_and_b32 s95, s2, 7
    v_xor_b32 v211, v211, v210
    s_mul_i32 s94, s95, 31
    v_and_b32 v213, 7, v0
    s_min_u32 s95, s95, 2
    v_bfe_u32 v214, v0, 3, 3
    s_add_u32 s94, s94, s95
    v_mul_u32_u24 v213, 3, v213
    s_lshr_b32 s95, s2, 3
    v_min_u32 v214, 2, v214
    s_add_u32 s94, s94, s95
    v_add_lshl_u32 v213, v213, v214, 1
    s_mul_i32 s60, s94, 5
    s_add_u32 s60, s60, s3
    s_mul_i32 s60, s60, 48
    s_and_b32 s95, s3, 3
    s_lshl_b32 s95, s95, 6
    v_xor_b32 v211, s95, v211
    s_lshl_b32 s95, s3, 4
    v_xor_b32 v214, s95, v210
    s_mul_i32 s94, s94, 10240
    s_lshl_b32 s61, s3, 10
    s_lshl_b32 s62, s3, 8
    s_add_u32 s62, s62, 8192
    s_add_u32 s95, s94, s62
    s_add_u32 s94, s94, s61
    s_mov_b32 m0, s61
    buffer_load_ushort v209, v213, s[88:91], s60 offen
    buffer_load_dwordx4 v211, s[56:59], s94 offen lds
    s_mov_b32 m0, s62
    s_mov_b64 exec, 0xffff
    buffer_load_dwordx4 v214, s[56:59], s95 offen lds
    s_mov_b64 exec, -1
    s_mov_b32 s4, 262144
    s_cmp_lg_u32 s3, 0
    s_cbranch_scc1 F_W2
    s_sleep 40
F_W1:
    global_load_dword v2, v1, s[96:97] sc1
    s_sub_u32 s4, s4, 1
    s_cbranch_scc1 F_W2
    s_sleep 8
    s_waitcnt vmcnt(0)
    v_cmp_ne_u32 vcc, 0x1, v2
    s_cbranch_vccnz F_W1
F_W2:
    s_waitcnt vmcnt(0)
    s_barrier
    s_branch F_COMMON
.p2align 8
K2_ENTRY:
    s_mov_b32 s98, 1
    s_mov_b64 exec, -1
F_COMMON:
    v_readfirstlane_b32 s3, v0
    v_mov_b32 v184, 0
    v_mov_b32 v185, 1
    s_cmp_gt_u32 s98, s3
    s_cbranch_scc0 F_NRD
    global_load_dword v185, v184, s[96:97] sc1
F_NRD:
    v_lshlrev_b32 v78, 4, v0
    v_and_b32 v78, 0x3f0, v78
    v_add_u32 v78, 128256, v78
    ds_read_b128 v[216:219], v78 offset:5120
    s_waitcnt lgkmcnt(0)
    s_mov_b32 s100, s2
    s_load_dwordx2 s[16:17], s[0:1], 56
    s_load_dwordx2 s[36:37], s[0:1], 80
    s_load_dwordx2 s[32:33], s[0:1], 64
    s_getpc_b64 s[30:31]
K2_PC:
    v_readfirstlane_b32 s3, v0
    s_add_u32 s30, s30, K2_TAB+4096-K2_PC
    v_lshlrev_b32 v71, 4, v0
    s_addc_u32 s31, s31, 0
    v_and_b32 v1, 0x3f0, v71
    ds_read_b128 v[26:29], v78 offset:0
    ds_read_b128 v[228:231], v78 offset:1024
    ds_read_b128 v[6:9], v78 offset:2048
    s_load_dwordx16 s[44:59], s[30:31], s3 offset:2048
    s_load_dwordx16 s[60:75], s[30:31], s3 offset:2560
    s_load_dwordx8 s[4:11], s[30:31], s3 offset:3072
    ds_read_b128 v[2:5], v78 offset:3072
    ds_read_b128 v[10:13], v78 offset:4096
    v_mov_b64 v[64:65], 0
    v_mov_b64 v[66:67], 0
    ds_read_b128 v[80:83], v216 offset:0
    v_and_b32 v190, 48, v1
    s_and_b32 s13, s2, 7
    ds_read_b128 v[84:87], v216 offset:4096
    v_lshl_add_u32 v191, s3, 5, v1
    s_lshr_b32 s2, s2, 3
    ds_read_b128 v[88:91], v216 offset:8192
    v_and_b32 v68, 48, v1
    s_mul_i32 s14, s13, 31
    ds_read_b128 v[92:95], v217 offset:0
    v_lshrrev_b32 v60, 2, v0
    s_min_u32 s13, s13, 2
    ds_read_b128 v[128:131], v217 offset:4096
    v_mul_i32_i24 v70, -92160, v60
    s_add_u32 s14, s14, s13
    ds_read_b128 v[132:135], v217 offset:8192
    v_mul_u32_u24 v60, 46080, v60
    s_add_u32 s2, s2, s14
    ds_read_b128 v[136:139], v218 offset:0
    v_lshrrev_b32 v68, 2, v68
    s_mul_i32 s12, s2, 20
    ds_read_b128 v[140:143], v218 offset:4096
    v_add_u32 v61, v68, v60
    s_add_u32 s12, s12, 20480
    ds_read_b128 v[144:147], v218 offset:8192
    v_lshrrev_b32 v69, 1, v1
    s_mov_b32 s38, 11141120
    ds_read_b128 v[148:151], v219 offset:0
    s_mov_b32 s39, 0x00020000
    ds_read_b128 v[152:155], v219 offset:4096
    ds_read_b128 v[156:159], v219 offset:8192
    s_waitcnt lgkmcnt(0)
    s_and_b32 s37, s37, 0xffff
    v_xor_b32 v10, s69, v10
    v_xor_b32 v27, s69, v27
    s_and_b32 s101, s100, 7
    s_and_b32 s100, s100, 7
    v_lshl_add_u32 v186, v0, 8, s101
    s_mul_i32 s101, s101, 256
    v_lshlrev_b32 v187, 2, v0
    s_lshl_b32 s100, s100, 8
    v_min_u32 v187, 4, v187
    s_add_u32 s101, s101, 11108352
    s_add_u32 s100, s100, 11116544
    v_add_u32 v186, 11116544, v186
    v_mov_b32 v188, 1
    v_mov_b32 v189, 1
    s_mov_b32 s18, 65536
    s_mov_b32 s19, 0x00020000
    s_and_b32 s17, s17, 0xffff
    v_and_b32 v78, 48, v0
    s_lshl_b32 s15, s2, 20
    s_add_u32 s15, s15, s3
    s_lshl_b32 s15, s15, 4
    s_and_b32 s15, s15, 0x7fff
    v_lshlrev_b32 v78, 2, v78
    v_xor_b32 v78, v78, v1
    v_lshl_add_u32 v28, s3, 1, v28
    v_lshlrev_b32 v21, 16, v209
    v_add_u32 v22, 2560000, v29
    s_mul_i32 s13, s2, 10240
    s_cmp_ge_u32 s15, 8192
    s_cselect_b32 s57, 1280, 0
    s_add_u32 s57, s15, s57
    s_add_u32 m0, s57, 28672
    s_mul_i32 s14, s2, 240
    buffer_load_dwordx4 v78, s[16:19], s15 offen lds
    s_add_u32 s15, s15, 8192
    s_and_b32 s15, s15, 0x7fff
    s_cmp_ge_u32 s15, 8192
    s_cselect_b32 s57, 1280, 0
    s_add_u32 s57, s15, s57
    s_add_u32 m0, s57, 28672
    s_add_u32 s68, s68, s14
    buffer_load_dwordx4 v78, s[16:19], s15 offen lds
    s_add_u32 s15, s15, 8192
    s_and_b32 s15, s15, 0x7fff
    s_cmp_ge_u32 s15, 8192
    s_cselect_b32 s57, 1280, 0
    s_add_u32 s57, s15, s57
    s_add_u32 m0, s57, 28672
    v_sub_u32 v62, s9, v70
    buffer_load_dwordx4 v78, s[16:19], s15 offen lds
    s_add_u32 s15, s15, 8192
    s_and_b32 s15, s15, 0x7fff
    s_cmp_ge_u32 s15, 8192
    s_cselect_b32 s57, 1280, 0
    s_add_u32 s57, s15, s57
    s_add_u32 m0, s57, 28672
    v_add_u32 v228, v228, v62
    buffer_load_dwordx4 v78, s[16:19], s15 offen lds
    s_waitcnt vmcnt(4)
    v_cmp_ne_u32 vcc, 0x1, v185
    s_cbranch_vccnz F_RL
F_RDY:
    s_cmp_gt_u32 s98, s3
    s_barrier
    s_cbranch_scc0 F_NSIG
    s_mov_b64 exec, 1
    buffer_atomic_add v189, off, s[36:39], s101 sc0 sc1
    s_mov_b64 exec, -1
F_NSIG:
    s_mov_b32 m0, s59
    s_waitcnt vmcnt(0)
    v_readfirstlane_b32 s56, v189
    s_cmp_lg_u32 s56, 28
    s_cbranch_scc1 F_NLAST
    s_mov_b32 exec_lo, 0xff
    s_mov_b32 exec_hi, 0
    buffer_store_byte v188, v186, s[36:39], 0 offen sc1
    s_mov_b64 exec, -1
F_NLAST:
    s_barrier
    ds_read_b64_tr_b16 v[240:241], v27 offset:28672
    v_add_u32 v229, v229, v62
    v_add_u32 v25, s10, v8
    ds_read_b64_tr_b16 v[242:243], v27 offset:29696
    s_mov_b32 s34, 2620000
    s_mov_b32 s35, 0x00020000
    ds_read_b64_tr_b16 v[244:245], v27 offset:38144
    s_mov_b32 s42, 65536
    s_mov_b32 s43, 0x00020000
    ds_read_b64_tr_b16 v[246:247], v27 offset:39168
    s_and_b32 s33, s33, 0xffff
    s_mov_b32 s40, s36
    ds_read_b64_tr_b16 v[248:249], v27 offset:46336
    s_or_b32 s41, s37, 0x1000000
    s_add_u32 s69, s69, s13
    ds_read_b64_tr_b16 v[250:251], v27 offset:47360
    v_add_u32 v231, s72, v231
    v_mov_b32 v76, 0x3f80
    ds_read_b64_tr_b16 v[252:253], v27 offset:54528
    v_add_u32 v16, s6, v8
    v_add_u32 v14, s59, v3
    ds_read_b64_tr_b16 v[254:255], v27 offset:55552
    v_add_u32 v2, s59, v2
    v_xor_b32 v15, 16, v14
    ds_write_b128 v190, v[64:67] offset:36864
    v_xor_b32 v3, 32, v2
    v_add_u32 v24, s59, v8
    ds_write_b128 v191, v[64:67] offset:12288
    v_mov_b32 v18, v13
    v_mov_b32 v19, v13
    ds_read_b64 v[220:221], v10 offset:0
    v_add_u32 v20, 16384, v13
    v_mov_b32 v53, v9
    ds_read_b64 v[222:223], v10 offset:4096
    v_mov_b32 v55, v9
    v_mov_b64 v[192:193], 0
    ds_read_b64 v[224:225], v10 offset:8192
    v_mov_b64 v[194:195], 0
    v_mov_b64 v[196:197], 0
    ds_write_b32 v28, v21 offset:36928
    v_mov_b64 v[198:199], 0
    v_mov_b64 v[160:161], 0
    v_mov_b64 v[162:163], 0
    v_mov_b64 v[164:165], 0
    v_mov_b64 v[166:167], 0
    v_mov_b64 v[168:169], 0
    v_mov_b64 v[170:171], 0
    v_mov_b64 v[172:173], 0
    v_mov_b64 v[174:175], 0
    v_mov_b64 v[176:177], 0
    v_mov_b64 v[178:179], 0
    v_mov_b64 v[180:181], 0
    v_mov_b64 v[182:183], 0
    v_mov_b64 v[30:31], 0
    v_mov_b64 v[32:33], 0
    v_mov_b64 v[34:35], 0
    v_mov_b64 v[36:37], 0
    v_lshlrev_b32 v77, v1, v76
    s_mov_b32 s30, 3
    s_mov_b32 s31, 0x30000
    s_lshl_b64 exec, s[30:31], 0
    v_mov_b32 v30, v77
    s_lshl_b64 exec, s[30:31], 2
    v_mov_b32 v31, v77
    s_lshl_b64 exec, s[30:31], 8
    v_mov_b32 v32, v77
    s_lshl_b64 exec, s[30:31], 10
    v_mov_b32 v33, v77
    s_lshl_b64 exec, s[30:31], 4
    v_mov_b32 v34, v77
    s_lshl_b64 exec, s[30:31], 6
    v_mov_b32 v35, v77
    s_lshl_b64 exec, s[30:31], 12
    v_mov_b32 v36, v77
    s_lshl_b64 exec, s[30:31], 14
    v_mov_b32 v37, v77
    s_mov_b64 exec, -1
    s_waitcnt lgkmcnt(6)
    s_waitcnt vmcnt(63)
    v_mfma_f32_16x16x32_bf16 v[208:211], v[240:243], v[80:83], 0
    v_mfma_f32_16x16x32_bf16 v[212:215], v[240:243], v[84:87], 0
    v_mfma_f32_16x16x32_bf16 v[216:219], v[240:243], v[88:91], 0
    v_mfma_f32_16x16x32_bf16 v[208:211], v[244:247], v[92:95], v[208:211]
    v_mfma_f32_16x16x32_bf16 v[212:215], v[244:247], v[128:131], v[212:215]
    v_mfma_f32_16x16x32_bf16 v[216:219], v[244:247], v[132:135], v[216:219]
    v_mfma_f32_16x16x32_bf16 v[208:211], v[248:251], v[136:139], v[208:211]
    v_mfma_f32_16x16x32_bf16 v[212:215], v[248:251], v[140:143], v[212:215]
    v_mfma_f32_16x16x32_bf16 v[216:219], v[248:251], v[144:147], v[216:219]
    v_mfma_f32_16x16x32_bf16 v[208:211], v[252:255], v[148:151], v[208:211]
    v_mov_b64 v[80:81], 0
    v_mfma_f32_16x16x32_bf16 v[212:215], v[252:255], v[152:155], v[212:215]
    v_mov_b64 v[82:83], 0
    v_mfma_f32_16x16x32_bf16 v[216:219], v[252:255], v[156:159], v[216:219]
    v_mov_b64 v[84:85], 0
    v_mov_b64 v[86:87], 0
    v_mov_b64 v[88:89], 0
    v_mov_b64 v[90:91], 0
    v_mov_b64 v[92:93], 0
    v_mov_b64 v[94:95], 0
    s_mov_b32 s56, 0xbfb8aa3b
    v_mov_b64 v[242:243], 0
    v_pk_mul_f32 v[208:209], v[208:209], s[56:57] op_sel_hi:[1,0]
    v_pk_mul_f32 v[210:211], v[210:211], s[56:57] op_sel_hi:[1,0]
    v_pk_mul_f32 v[212:213], v[212:213], s[56:57] op_sel_hi:[1,0]
    v_pk_mul_f32 v[214:215], v[214:215], s[56:57] op_sel_hi:[1,0]
    v_pk_mul_f32 v[216:217], v[216:217], s[56:57] op_sel_hi:[1,0]
    v_pk_mul_f32 v[218:219], v[218:219], s[56:57] op_sel_hi:[1,0]
    ds_write_b128 v71, v[64:67] offset:62720
    v_add_u32 v71, 70912, v71
    ds_write_b128 v71, v[64:67] offset:0
    ds_write_b128 v71, v[64:67] offset:8192
    ds_write_b128 v71, v[64:67] offset:16384
    ds_write_b128 v71, v[64:67] offset:24576
    ds_write_b128 v71, v[64:67] offset:32768
    v_mov_b64 v[28:29], 0
    v_mov_b32 v27, 0
    s_cmp_lg_u32 s3, 0
    s_cbranch_scc1 F_GO
    s_mov_b32 s99, 262144
F_POLL:
    buffer_load_dword v185, v187, s[36:39], s100 offen sc1
    s_sub_u32 s99, s99, 1
    s_cbranch_scc1 F_GO
F_PCK:
    s_waitcnt vmcnt(0)
    v_cmp_ne_u32 vcc, 0x1010101, v185
    s_cbranch_vccnz F_POLL
F_GO:
    s_mov_b32 s38, 5760000
    s_waitcnt vmcnt(0) lgkmcnt(0)
    s_barrier
    buffer_load_dwordx2 v[72:73], v61, s[36:39], s12 offen
    buffer_load_dwordx2 v[74:75], v60, s[36:39], s12 offen offset:16
    s_mov_b32 s38, 11141120
    ds_write_b128 v71, v[64:67] offset:40960
    s_add_u32 s7, s7, s13
    buffer_load_dwordx2 v[42:43], v69, s[36:39], s7 offen offset:0
    s_add_u32 s12, s7, 4096
    ds_write_b128 v71, v[64:67] offset:49152
    buffer_load_dwordx2 v[44:45], v69, s[36:39], s7 offen offset:2048
    s_add_u32 s15, s7, 8192
    buffer_load_dwordx2 v[46:47], v69, s[36:39], s12 offen offset:0
    ds_write_b128 v71, v[64:67] offset:57344
    buffer_load_dwordx2 v[48:49], v69, s[36:39], s12 offen offset:2048
    buffer_load_dwordx2 v[50:51], v69, s[36:39], s15 offen offset:0
    s_waitcnt vmcnt(5)
    v_mov_b32_dpp v61, v72 quad_perm:[0,0,0,0] row_mask:0xf bank_mask:0xf
    v_sub_u32_sdwa v63, s72, v75 dst_sel:DWORD dst_unused:UNUSED_PAD src0_sel:DWORD src1_sel:WORD_0
    v_sub_u32_sdwa v62, v75, v61 dst_sel:DWORD dst_unused:UNUSED_PAD src0_sel:WORD_0 src1_sel:WORD_0
    v_bfe_u32 v234, v74, v230, 16
    v_sub_u32_sdwa v226, v73, v72 dst_sel:DWORD dst_unused:UNUSED_PAD src0_sel:WORD_0 src1_sel:WORD_0
    v_add_u32_dpp v62, v62, v62 row_shr:4 row_mask:0xf bank_mask:0xf bound_ctrl:0
    v_sub_u32_sdwa v227, v75, v74 dst_sel:DWORD dst_unused:UNUSED_PAD src0_sel:WORD_0 src1_sel:WORD_0
    v_sub_u32_sdwa v61, v73, v61 dst_sel:DWORD dst_unused:UNUSED_PAD src0_sel:WORD_0 src1_sel:WORD_0
    v_add_u32_dpp v62, v62, v62 row_shr:8 row_mask:0xf bank_mask:0xf bound_ctrl:0
    v_lshlrev_b32 v61, 2, v61
    s_nop 0
    v_add_u32_dpp v62, v62, v62 row_bcast:15 row_mask:0xa bank_mask:0xf
    v_add_u32_dpp v61, v61, v61 row_shr:4 row_mask:0xf bank_mask:0xf bound_ctrl:0
    s_nop 0
    v_add_u32_dpp v62, v62, v62 row_bcast:31 row_mask:0xc bank_mask:0xf
    v_add_u32_dpp v61, v61, v61 row_shr:8 row_mask:0xf bank_mask:0xf bound_ctrl:0
    v_add_u32 v63, v62, v63
    v_add_u32_sdwa v232, v63, v72 dst_sel:DWORD dst_unused:UNUSED_PAD src0_sel:DWORD src1_sel:WORD_0
    v_mad_i32_i24 v228, v63, -4, v228
    v_add_u32_sdwa v233, v63, v72 dst_sel:DWORD dst_unused:UNUSED_PAD src0_sel:DWORD src1_sel:WORD_1
    v_add_u32 v234, v63, v234
    v_mad_i32_i24 v229, v63, -4, v229
    v_readlane_b32 s82, v62, 63
K2_BATCH:
    v_add_u32 v119, 0x1000000, v228
    v_min_i32 v116, s64, v232
    ds_max_u32 v116, v228
    v_min_i32 v117, s64, v233
    ds_max_u32 v117, v119
    v_min_i32 v118, s64, v234
    ds_max_u32 v118, v229
    ds_read2st64_b32 v[112:113], v25 offset0:0 offset1:1
    ds_read2st64_b32 v[114:115], v25 offset0:2 offset1:3
    s_add_u32 s57, s82, s72
    v_cmp_gt_i32 s[16:17], s57, v25
    s_sub_u32 s57, s57, 256
    v_cmp_gt_i32 s[26:27], s57, v25
    s_sub_u32 s57, s57, 256
    v_cmp_gt_i32 s[28:29], s57, v25
    s_sub_u32 s57, s57, 256
    v_cmp_gt_i32 s[18:19], s57, v25
    s_or_b32 s0, s54, s55
    s_waitcnt lgkmcnt(0)
    v_max_u32_dpp v112, v112, v112 row_shr:1 row_mask:0xf bank_mask:0xf bound_ctrl:0
    v_max_u32_dpp v113, v113, v113 row_shr:1 row_mask:0xf bank_mask:0xf bound_ctrl:0
    v_max_u32_dpp v114, v114, v114 row_shr:1 row_mask:0xf bank_mask:0xf bound_ctrl:0
    v_max_u32_dpp v112, v112, v112 row_shr:2 row_mask:0xf bank_mask:0xf bound_ctrl:0
    v_max_u32_dpp v113, v113, v113 row_shr:2 row_mask:0xf bank_mask:0xf bound_ctrl:0
    v_max_u32_dpp v114, v114, v114 row_shr:2 row_mask:0xf bank_mask:0xf bound_ctrl:0
    v_max_u32_dpp v112, v112, v112 row_shr:4 row_mask:0xf bank_mask:0xf bound_ctrl:0
    v_max_u32_dpp v113, v113, v113 row_shr:4 row_mask:0xf bank_mask:0xf bound_ctrl:0
    v_max_u32_dpp v114, v114, v114 row_shr:4 row_mask:0xf bank_mask:0xf bound_ctrl:0
    v_max_u32_dpp v112, v112, v112 row_shr:8 row_mask:0xf bank_mask:0xf bound_ctrl:0
    v_max_u32_dpp v113, v113, v113 row_shr:8 row_mask:0xf bank_mask:0xf bound_ctrl:0
    v_max_u32_dpp v114, v114, v114 row_shr:8 row_mask:0xf bank_mask:0xf bound_ctrl:0
    v_max_u32_dpp v112, v112, v112 row_bcast:15 row_mask:0xa bank_mask:0xf
    v_max_u32_dpp v113, v113, v113 row_bcast:15 row_mask:0xa bank_mask:0xf
    v_max_u32_dpp v114, v114, v114 row_bcast:15 row_mask:0xa bank_mask:0xf
    v_max_u32_dpp v112, v112, v112 row_bcast:31 row_mask:0xc bank_mask:0xf
    v_max_u32_dpp v113, v113, v113 row_bcast:31 row_mask:0xc bank_mask:0xf
    v_max_u32_dpp v114, v114, v114 row_bcast:31 row_mask:0xc bank_mask:0xf
    v_readlane_b32 s56, v112, 63
    v_readlane_b32 s58, v113, 63
    v_mad_u32_u24 v116, v112, 1, v1
    v_lshrrev_b32 v124, 1, v116
    buffer_load_dwordx2 v[98:99], v124, s[36:39], s66 offen offset:0
    buffer_load_dwordx2 v[96:97], v124, s[36:39], 0 offen offset:0
    v_max_u32 v113, s56, v113
    s_max_u32 s58, s58, s56
    v_mad_u32_u24 v117, v113, 1, v1
    v_lshrrev_b32 v125, 1, v117
    buffer_load_dwordx2 v[102:103], v125, s[36:39], s66 offen offset:512
    buffer_load_dwordx2 v[100:101], v125, s[36:39], 0 offen offset:512
    v_max_u32 v114, s58, v114
    s_cmpk_gt_i32 s82, 768
    v_mad_u32_u24 v118, v114, 1, v1
    v_lshrrev_b32 v126, 1, v118
    buffer_load_dwordx2 v[106:107], v126, s[36:39], s66 offen offset:1024
    buffer_load_dwordx2 v[104:105], v126, s[36:39], 0 offen offset:1024
    s_cbranch_scc1 K2_PA4
K2_PA_DONE:
    s_cmp_lg_u32 s0, 0
    v_add_u32 v117, 1024, v117
    v_add_u32 v118, 2048, v118
    s_cbranch_scc1 K2_NOTFIRST
    ds_add_rtn_u32 v226, v68, v226 offset:36864
    s_mov_b32 exec_lo, 0x11111111
    s_mov_b32 exec_hi, 0x11111111
    ds_add_rtn_u32 v227, v68, v227 offset:36880
    s_mov_b32 exec_lo, 0xf000f000
    s_mov_b32 exec_hi, 0xf000f000
    ds_add_u32 v68, v61 offset:36912
    s_mov_b64 exec, -1
    v_lshrrev_b32 v120, 25, v112
    v_lshrrev_b32 v124, 18, v112
    v_lshl_add_u32 v120, v120, 2, s72
    v_and_b32 v124, 0x3c0, v124
    v_and_b32 v235, 28, v120
    v_lshlrev_b32 v56, 9, v235
    v_lshrrev_b32 v121, 25, v113
    v_lshrrev_b32 v125, 18, v113
    v_lshl_add_u32 v121, v121, 2, s72
    v_and_b32 v125, 0x3c0, v125
    v_and_b32 v236, 28, v121
    v_lshlrev_b32 v57, 9, v236
    v_lshrrev_b32 v122, 25, v114
    v_lshrrev_b32 v126, 18, v114
    v_lshl_add_u32 v122, v122, 2, s72
    v_and_b32 v126, 0x3c0, v126
    v_and_b32 v237, 28, v122
    v_lshlrev_b32 v58, 9, v237
    s_waitcnt lgkmcnt(1)
    v_sub_u32_sdwa v226, v226, v72 dst_sel:DWORD dst_unused:UNUSED_PAD src0_sel:DWORD src1_sel:WORD_0
    v_sub_u32_sdwa v227, v227, v74 dst_sel:DWORD dst_unused:UNUSED_PAD src0_sel:DWORD src1_sel:WORD_0
    v_lshl_add_u32 v226, v226, 2, v70
    v_lshl_add_u32 v227, v227, 2, v70
    ds_write2_b32 v231, v226, v227 offset0:0 offset1:4
    ds_read_b32 v120, v120 offset:1280
    ds_read_b32 v121, v121 offset:1280
    ds_read_b32 v122, v122 offset:1280
    s_waitcnt lgkmcnt(4)
    s_barrier
    ds_read_b32 v17, v8 offset:33792
    ds_read_b32 v235, v235 offset:36908
    ds_read_b32 v236, v236 offset:36908
    ds_read_b32 v237, v237 offset:36908
    buffer_load_dwordx2 v[40:41], v1, s[36:39], s8 offen offset:2048
    buffer_load_dwordx4 v[204:207], v1, s[36:39], s8 offen offset:1024
    buffer_load_dwordx4 v[200:203], v1, s[36:39], s8 offen offset:0
    s_waitcnt lgkmcnt(0)
    v_cmp_gt_u32 vcc, 512, v17
    v_readlane_b32 s11, v17, 4
    v_readlane_b32 s10, v17, 15
    v_lshrrev_b32 v238, 9, v17
    s_movk_i32 s57, 1280
    s_lshl2_add_u32 s11, s11, s10
    s_and_b32 s56, vcc_lo, 31
    s_cbranch_scc1 K2_GEN
    s_cmpk_gt_u32 s11, 22528
    s_cbranch_scc1 K2_GEN
    v_lshl_add_u32 v239, v0, 4, s11
    v_readlane_b32 s9, v238, 14
    v_readlane_b32 s7, v238, 12
    v_readlane_b32 s8, v238, 13
    v_add3_u32 v116, v116, v120, v235
    s_add_u32 s11, s11, 511
    v_lshl_add_u32 v120, v116, 2, v56
    s_lshr_b32 s11, s11, 9
    v_bfe_u32 v112, v116, 4, 3
    s_lshr_b32 s10, s10, 9
    v_and_b32 v120, 0xfffffe00, v120
    s_mul_i32 s79, s11, 185
    v_lshl_or_b32 v120, v112, 1, v120
    s_add_u32 s79, s79, 255
    v_cmp_gt_u32 s[24:25], s57, v116
    s_lshr_b32 s79, s79, 8
    v_add3_u32 v117, v117, v121, v236
    s_add_u32 s56, s9, 3
    v_lshl_add_u32 v121, v117, 2, v57
    s_max_u32 s79, s79, s56
    v_bfe_u32 v113, v117, 4, 3
    s_sub_u32 s56, s10, 1
    v_and_b32 v121, 0xfffffe00, v121
    s_min_u32 s79, s79, s56
    v_lshl_or_b32 v121, v113, 1, v121
    s_cmp_lg_u32 s5, 0
    v_cmp_gt_u32 s[0:1], s57, v117
    v_add3_u32 v118, v118, v122, v237
    v_lshl_add_u32 v122, v118, 2, v58
    v_bfe_u32 v114, v118, 4, 3
    v_and_b32 v122, 0xfffffe00, v122
    v_lshl_or_b32 v122, v114, 1, v122
    v_cmp_gt_u32 vcc, s57, v118
    s_waitcnt vmcnt(9)
    s_cbranch_scc1 K2_G1
    s_mov_b32 s13, s79
    v_mov_b64 v[38:39], v[42:43]
    s_bitset1_b64 s[48:49], s7
    s_bitset1_b64 s[48:49], s8
    s_bitset1_b64 s[48:49], s9
    s_cmpk_ge_u32 s3, 128
    s_cbranch_scc1 K2_G2
    ds_write_b128 v239, v[192:195] offset:37888
    s_branch K2_G2
K2_G1:
    s_lshl_b32 s56, s79, 9
    v_mov_b64 v[38:39], v[48:49]
    s_lshl2_add_u32 s57, s56, 6144
    v_add_u32 v6, s56, v6
    s_sub_u32 s13, s11, s79
    v_add_u32 v5, s56, v5
    s_sub_u32 s58, s10, s79
    v_add_u32 v4, s57, v4
    s_bitset1_b64 s[48:49], s58
    v_add_u32 v7, s57, v7
K2_G2:
    s_lshl_b64 s[22:23], s[48:49], 1
    s_lshr_b64 s[48:49], s[48:49], 1
    s_or_b64 s[20:21], s[48:49], s[22:23]
    s_sub_u32 s12, s13, 1
    s_bitset1_b64 s[20:21], s12
    s_ff1_i32_b64 s15, s[20:21]
    s_mov_b32 s12, s15
K2_JAD:
    s_cmpk_gt_i32 s82, 768
    s_cbranch_scc1 K2_AD4
K2_AD4D:
    s_waitcnt vmcnt(3)
    v_lshrrev_b32 v112, 26, v99
    v_and_or_b32 v124, v112, 48, v124
    ds_read_b128 v[60:63], v124 offset:36928
    v_lshrrev_b32 v113, 26, v103
    v_and_or_b32 v125, v113, 48, v125
    ds_read_b128 v[64:67], v125 offset:36928
    v_lshrrev_b32 v114, 26, v107
    v_and_or_b32 v126, v114, 48, v126
    ds_read_b128 v[68:71], v126 offset:36928
    s_mov_b64 exec, s[16:17]
    v_and_or_b32 v120, v124, s63, v120
    ds_write_b16 v120, v76 offset:62720
    s_and_b64 exec, s[24:25], s[16:17]
    v_bfe_u32 v112, v99, 16, 14
    buffer_load_dword v238, v112, s[40:43], s75 idxen
    buffer_load_dword v239, v112, s[40:43], s75 idxen offset:128
    s_mov_b64 exec, s[26:27]
    v_and_or_b32 v121, v125, s63, v121
    ds_write_b16 v121, v76 offset:62720
    s_and_b64 exec, s[0:1], s[26:27]
    v_bfe_u32 v113, v103, 16, 14
    buffer_load_dword v238, v113, s[40:43], s75 idxen
    buffer_load_dword v239, v113, s[40:43], s75 idxen offset:128
    s_mov_b64 exec, s[28:29]
    v_and_or_b32 v122, v126, s63, v122
    ds_write_b16 v122, v76 offset:62720
    s_and_b64 exec, vcc, s[28:29]
    v_bfe_u32 v114, v107, 16, 14
    buffer_load_dword v238, v114, s[40:43], s75 idxen
    buffer_load_dword v239, v114, s[40:43], s75 idxen offset:128
    s_mov_b64 exec, -1
    s_waitcnt lgkmcnt(3)
    v_dot2_f32_bf16 v60, v98, s70, v60
    v_dot2_f32_bf16 v61, v98, s71, v61
    v_dot2_f32_bf16 v62, v99, s70, v62
    v_dot2_f32_bf16 v64, v102, s70, v64
    v_dot2_f32_bf16 v65, v102, s71, v65
    v_dot2_f32_bf16 v66, v103, s70, v66
    v_dot2_f32_bf16 v68, v106, s70, v68
    v_dot2_f32_bf16 v69, v106, s71, v69
    v_dot2_f32_bf16 v70, v107, s70, v70
    v_cvt_pk_bf16_f32 v61, v60, v61
    v_cvt_pk_bf16_f32 v62, v62, 0
    s_mov_b64 exec, s[16:17]
    v_dot2_f32_bf16 v60, v61, v61, 0
    ds_write_b16 v120, v61 offset:62848
    v_dot2_f32_bf16 v60, v62, v62, v60
    ds_write_b16_d16_hi v120, v61 offset:62976
    ds_write_b16 v120, v62 offset:63104
    v_cvt_pk_bf16_f32 v65, v64, v65
    v_cvt_pk_bf16_f32 v66, v66, 0
    s_mov_b64 exec, s[26:27]
    v_dot2_f32_bf16 v64, v65, v65, 0
    ds_write_b16 v121, v65 offset:62848
    v_dot2_f32_bf16 v64, v66, v66, v64
    ds_write_b16_d16_hi v121, v65 offset:62976
    ds_write_b16 v121, v66 offset:63104
    v_cvt_pk_bf16_f32 v69, v68, v69
    v_cvt_pk_bf16_f32 v70, v70, 0
    s_mov_b64 exec, s[28:29]
    v_dot2_f32_bf16 v68, v69, v69, 0
    ds_write_b16 v122, v69 offset:62848
    v_dot2_f32_bf16 v68, v70, v70, v68
    ds_write_b16_d16_hi v122, v69 offset:62976
    ds_write_b16 v122, v70 offset:63104
    s_mov_b64 exec, s[16:17]
    v_mul_f32 v60, 0xbfb8aa3b, v60
    v_cvt_pk_bf16_f32 v60, v60, 0
    v_and_or_b32 v98, v99, s65, v60
    ds_write_b128 v116, v[96:99] offset:37888
    s_mov_b64 exec, s[26:27]
    v_mul_f32 v64, 0xbfb8aa3b, v64
    v_cvt_pk_bf16_f32 v64, v64, 0
    v_and_or_b32 v102, v103, s65, v64
    ds_write_b128 v117, v[100:103] offset:37888
    s_mov_b64 exec, s[28:29]
    v_mul_f32 v68, 0xbfb8aa3b, v68
    v_cvt_pk_bf16_f32 v68, v68, 0
    v_and_or_b32 v106, v107, s65, v68
    ds_write_b128 v118, v[104:107] offset:37888
    s_mov_b64 exec, -1
    s_cmpk_gt_i32 s82, 768
    s_cbranch_scc1 K2_REC4
K2_REC4D:
    s_cmp_lg_u32 s73, 0
    s_mov_b64 vcc, -1
    s_cbranch_scc1 K2_GCONT
    s_waitcnt lgkmcnt(0)
    s_barrier
    ds_read_u16 v8, v6 offset:0
    ds_read_u16 v10, v6 offset:256
    ds_read_u16 v52, v6 offset:512
    ds_read_u16 v54, v6 offset:768
    ds_read_b64_tr_b16 v[60:61], v4 offset:0
    ds_read_b64 v[62:63], v5 offset:0
    s_waitcnt lgkmcnt(4)
    buffer_load_dwordx4 v[8:9], s[40:43], s44 idxen offen offset:0 lds
    buffer_load_dwordx4 v[10:11], s[40:43], s45 idxen offen offset:1024 lds
    s_waitcnt lgkmcnt(2)
    buffer_load_dwordx4 v[52:53], s[40:43], s46 idxen offen offset:2048 lds
    buffer_load_dwordx4 v[54:55], s[40:43], s47 idxen offen offset:3072 lds
    ds_read_u16 v8, v6 offset:1024
    ds_read_u16 v10, v6 offset:1280
K2_JOIN:
    s_waitcnt vmcnt(2)
    ds_read_b128 v[52:55], v2 offset:0
    ds_read_b128 v[56:59], v3 offset:0
    s_waitcnt lgkmcnt(0)
    v_mfma_f32_32x32x16_bf16 v[96:111], v[52:55], v[30:33], 0
    buffer_load_dwordx4 v[8:9], s[40:43], s44 idxen offen offset:0 lds
    v_mfma_f32_32x32x16_bf16 v[96:111], v[56:59], v[34:37], v[96:111]
    buffer_load_dwordx4 v[10:11], s[40:43], s45 idxen offen offset:1024 lds
    v_mfma_f32_32x32x16_bf16 v[96:111], v[60:63], v[38:41], v[96:111]
    s_nop 7
    s_nop 3
    v_exp_f32 v128, v96
    v_exp_f32 v129, v97
    v_exp_f32 v130, v98
    v_exp_f32 v131, v99
    v_exp_f32 v132, v100
    v_exp_f32 v133, v101
    v_exp_f32 v134, v102
    v_exp_f32 v135, v103
    s_waitcnt vmcnt(2)
    ds_read_b128 v[52:55], v2 offset:2048
    ds_read_b128 v[56:59], v3 offset:2048
    ds_read_b64_tr_b16 v[60:61], v4 offset:2048
    ds_read_b64 v[62:63], v5 offset:512
    ds_read_u16 v8, v6 offset:1536
    ds_read_u16 v10, v6 offset:1792
    v_exp_f32 v136, v104
    v_exp_f32 v137, v105
    v_exp_f32 v138, v106
    v_exp_f32 v139, v107
    v_exp_f32 v140, v108
    v_exp_f32 v141, v109
    v_exp_f32 v142, v110
    v_exp_f32 v143, v111
    s_nop 1
    v_mfma_f32_32x32x16_bf16 v[128:143], v[26:29], v[26:29], v[128:143]
    s_nop 7
    s_waitcnt lgkmcnt(0)
    s_sub_u32 s12, s12, 1
    s_cbranch_scc1 K2_EVF
K2_BKF:
    buffer_load_dwordx4 v[8:9], s[40:43], s46 idxen offen offset:2048 lds
    buffer_load_dwordx4 v[10:11], s[40:43], s47 idxen offen offset:3072 lds
    v_mfma_f32_32x32x16_bf16 v[112:127], v[52:55], v[30:33], 0
    v_rcp_f32 v128, v128
    v_rcp_f32 v129, v129
    v_rcp_f32 v130, v130
    v_rcp_f32 v131, v131
    v_mfma_f32_32x32x16_bf16 v[112:127], v[56:59], v[34:37], v[112:127]
    v_rcp_f32 v132, v132
    v_rcp_f32 v133, v133
    v_rcp_f32 v134, v134
    v_rcp_f32 v135, v135
    v_mfma_f32_32x32x16_bf16 v[112:127], v[60:63], v[38:41], v[112:127]
    v_rcp_f32 v136, v136
    v_rcp_f32 v137, v137
    v_rcp_f32 v138, v138
    v_rcp_f32 v139, v139
    v_rcp_f32 v140, v140
    v_rcp_f32 v141, v141
    v_rcp_f32 v142, v142
    v_rcp_f32 v143, v143
    v_exp_f32 v144, v112
    v_exp_f32 v145, v113
    s_branch K2_L1B
.p2align 6
    s_nop 0
    s_nop 0
    s_nop 0
    s_nop 0
    s_nop 0
K2_LOOP:
    v_exp_f32 v128, v96
    v_exp_f32 v129, v97
    v_mfma_f32_32x32x16_bf16 v[80:95], v[76:79], v[68:71], v[80:95]
    v_exp_f32 v130, v98
    v_exp_f32 v131, v99
    v_exp_f32 v132, v100
    v_exp_f32 v133, v101
    v_exp_f32 v134, v102
    v_exp_f32 v135, v103
    s_waitcnt vmcnt(2)
    ds_read_b128 v[52:55], v2 offset:2048
    ds_read_b128 v[56:59], v3 offset:2048
    ds_read_b128 v[64:67], v7 offset:0
    ds_read_b128 v[68:71], v7 offset:1024
    ds_read_b64_tr_b16 v[60:61], v4 offset:2048
    ds_read_b64 v[62:63], v5 offset:512
    ds_read_u16 v8, v6 offset:1536
    ds_read_u16 v10, v6 offset:1792
    v_exp_f32 v136, v104
    v_exp_f32 v137, v105
    v_exp_f32 v138, v106
    v_exp_f32 v139, v107
    v_exp_f32 v140, v108
    v_exp_f32 v141, v109
    v_exp_f32 v142, v110
    v_exp_f32 v143, v111
    v_pk_mul_f32 v[144:145], v[144:145], v[112:113]
    v_pk_mul_f32 v[146:147], v[146:147], v[114:115]
    v_pk_mul_f32 v[148:149], v[148:149], v[116:117]
    v_pk_mul_f32 v[150:151], v[150:151], v[118:119]
    v_pk_mul_f32 v[152:153], v[152:153], v[120:121]
    v_pk_mul_f32 v[154:155], v[154:155], v[122:123]
    v_pk_mul_f32 v[156:157], v[156:157], v[124:125]
    v_pk_mul_f32 v[158:159], v[158:159], v[126:127]
    v_mfma_f32_32x32x16_bf16 v[128:143], v[26:29], v[26:29], v[128:143]
    v_cvt_pk_bf16_f32 v72, v144, v145
    v_cvt_pk_bf16_f32 v73, v146, v147
    v_cvt_pk_bf16_f32 v74, v148, v149
    v_cvt_pk_bf16_f32 v75, v150, v151
    v_cvt_pk_bf16_f32 v76, v152, v153
    v_cvt_pk_bf16_f32 v77, v154, v155
    v_cvt_pk_bf16_f32 v78, v156, v157
    v_cvt_pk_bf16_f32 v79, v158, v159
    s_waitcnt lgkmcnt(0)
    s_sub_u32 s12, s12, 1
    s_cbranch_scc1 K2_EV0
K2_BK0:
    buffer_load_dwordx4 v[8:9], s[40:43], s46 idxen offen offset:2048 lds
    buffer_load_dwordx4 v[10:11], s[40:43], s47 idxen offen offset:3072 lds
    v_mfma_f32_32x32x16_bf16 v[112:127], v[52:55], v[30:33], 0
    v_rcp_f32 v128, v128
    v_rcp_f32 v129, v129
    v_rcp_f32 v130, v130
    v_rcp_f32 v131, v131
    v_mfma_f32_32x32x16_bf16 v[112:127], v[56:59], v[34:37], v[112:127]
    v_rcp_f32 v132, v132
    v_rcp_f32 v133, v133
    v_rcp_f32 v134, v134
    v_rcp_f32 v135, v135
    v_mfma_f32_32x32x16_bf16 v[112:127], v[60:63], v[38:41], v[112:127]
    v_rcp_f32 v136, v136
    v_rcp_f32 v137, v137
    v_rcp_f32 v138, v138
    v_rcp_f32 v139, v139
    v_mfma_f32_32x32x16_bf16 v[80:95], v[72:75], v[64:67], v[80:95]
    v_rcp_f32 v140, v140
    v_rcp_f32 v141, v141
    v_rcp_f32 v142, v142
    v_rcp_f32 v143, v143
K2_L1:
    v_exp_f32 v144, v112
    v_exp_f32 v145, v113
    v_mfma_f32_32x32x16_bf16 v[80:95], v[76:79], v[68:71], v[80:95]
K2_L1B:
    v_exp_f32 v146, v114
    v_exp_f32 v147, v115
    v_exp_f32 v148, v116
    v_exp_f32 v149, v117
    v_exp_f32 v150, v118
    v_exp_f32 v151, v119
    s_waitcnt vmcnt(2)
    ds_read_b128 v[52:55], v2 offset:0
    ds_read_b128 v[56:59], v3 offset:0
    ds_read_b128 v[64:67], v7 offset:2048
    ds_read_b128 v[68:71], v7 offset:3072
    ds_read_b64_tr_b16 v[60:61], v4 offset:4096
    ds_read_b64 v[62:63], v5 offset:1024
    ds_read_u16 v8, v6 offset:2048
    ds_read_u16 v10, v6 offset:2304
    v_exp_f32 v152, v120
    v_exp_f32 v153, v121
    v_exp_f32 v154, v122
    v_exp_f32 v155, v123
    v_exp_f32 v156, v124
    v_exp_f32 v157, v125
    v_exp_f32 v158, v126
    v_exp_f32 v159, v127
    v_pk_mul_f32 v[128:129], v[128:129], v[96:97]
    v_pk_mul_f32 v[130:131], v[130:131], v[98:99]
    v_pk_mul_f32 v[132:133], v[132:133], v[100:101]
    v_pk_mul_f32 v[134:135], v[134:135], v[102:103]
    v_pk_mul_f32 v[136:137], v[136:137], v[104:105]
    v_pk_mul_f32 v[138:139], v[138:139], v[106:107]
    v_pk_mul_f32 v[140:141], v[140:141], v[108:109]
    v_pk_mul_f32 v[142:143], v[142:143], v[110:111]
    v_mfma_f32_32x32x16_bf16 v[144:159], v[26:29], v[26:29], v[144:159]
    v_cvt_pk_bf16_f32 v72, v128, v129
    v_cvt_pk_bf16_f32 v73, v130, v131
    v_cvt_pk_bf16_f32 v74, v132, v133
    v_cvt_pk_bf16_f32 v75, v134, v135
    v_cvt_pk_bf16_f32 v76, v136, v137
    v_cvt_pk_bf16_f32 v77, v138, v139
    v_cvt_pk_bf16_f32 v78, v140, v141
    v_cvt_pk_bf16_f32 v79, v142, v143
    s_waitcnt lgkmcnt(0)
    s_sub_u32 s12, s12, 1
    s_cbranch_scc1 K2_EV1
K2_BK1:
    buffer_load_dwordx4 v[8:9], s[40:43], s44 idxen offen offset:0 lds
    buffer_load_dwordx4 v[10:11], s[40:43], s45 idxen offen offset:1024 lds
    v_mfma_f32_32x32x16_bf16 v[96:111], v[52:55], v[30:33], 0
    v_rcp_f32 v144, v144
    v_rcp_f32 v145, v145
    v_rcp_f32 v146, v146
    v_rcp_f32 v147, v147
    v_mfma_f32_32x32x16_bf16 v[96:111], v[56:59], v[34:37], v[96:111]
    v_rcp_f32 v148, v148
    v_rcp_f32 v149, v149
    v_rcp_f32 v150, v150
    v_rcp_f32 v151, v151
    v_mfma_f32_32x32x16_bf16 v[96:111], v[60:63], v[38:41], v[96:111]
    v_rcp_f32 v152, v152
    v_rcp_f32 v153, v153
    v_rcp_f32 v154, v154
    v_rcp_f32 v155, v155
    v_mfma_f32_32x32x16_bf16 v[80:95], v[72:75], v[64:67], v[80:95]
    v_rcp_f32 v156, v156
    v_rcp_f32 v157, v157
    v_rcp_f32 v158, v158
    v_rcp_f32 v159, v159
K2_L2:
    v_exp_f32 v128, v96
    v_exp_f32 v129, v97
    v_mfma_f32_32x32x16_bf16 v[80:95], v[76:79], v[68:71], v[80:95]
    v_exp_f32 v130, v98
    v_exp_f32 v131, v99
    v_exp_f32 v132, v100
    v_exp_f32 v133, v101
    v_exp_f32 v134, v102
    v_exp_f32 v135, v103
    s_waitcnt vmcnt(2)
    ds_read_b128 v[52:55], v2 offset:2048
    ds_read_b128 v[56:59], v3 offset:2048
    ds_read_b128 v[64:67], v7 offset:4096
    ds_read_b128 v[68:71], v7 offset:5120
    ds_read_b64_tr_b16 v[60:61], v4 offset:6144
    ds_read_b64 v[62:63], v5 offset:1536
    ds_read_u16 v8, v6 offset:2560
    ds_read_u16 v10, v6 offset:2816
    v_exp_f32 v136, v104
    v_exp_f32 v137, v105
    v_exp_f32 v138, v106
    v_exp_f32 v139, v107
    v_exp_f32 v140, v108
    v_exp_f32 v141, v109
    v_exp_f32 v142, v110
    v_exp_f32 v143, v111
    v_pk_mul_f32 v[144:145], v[144:145], v[112:113]
    v_pk_mul_f32 v[146:147], v[146:147], v[114:115]
    v_pk_mul_f32 v[148:149], v[148:149], v[116:117]
    v_pk_mul_f32 v[150:151], v[150:151], v[118:119]
    v_pk_mul_f32 v[152:153], v[152:153], v[120:121]
    v_pk_mul_f32 v[154:155], v[154:155], v[122:123]
    v_pk_mul_f32 v[156:157], v[156:157], v[124:125]
    v_pk_mul_f32 v[158:159], v[158:159], v[126:127]
    v_mfma_f32_32x32x16_bf16 v[128:143], v[26:29], v[26:29], v[128:143]
    v_cvt_pk_bf16_f32 v72, v144, v145
    v_cvt_pk_bf16_f32 v73, v146, v147
    v_cvt_pk_bf16_f32 v74, v148, v149
    v_cvt_pk_bf16_f32 v75, v150, v151
    v_cvt_pk_bf16_f32 v76, v152, v153
    v_cvt_pk_bf16_f32 v77, v154, v155
    v_cvt_pk_bf16_f32 v78, v156, v157
    v_cvt_pk_bf16_f32 v79, v158, v159
    s_waitcnt lgkmcnt(0)
    s_sub_u32 s12, s12, 1
    s_cbranch_scc1 K2_EV2
K2_BK2:
    buffer_load_dwordx4 v[8:9], s[40:43], s46 idxen offen offset:2048 lds
    buffer_load_dwordx4 v[10:11], s[40:43], s47 idxen offen offset:3072 lds
    v_mfma_f32_32x32x16_bf16 v[112:127], v[52:55], v[30:33], 0
    v_rcp_f32 v128, v128
    v_rcp_f32 v129, v129
    v_rcp_f32 v130, v130
    v_rcp_f32 v131, v131
    v_mfma_f32_32x32x16_bf16 v[112:127], v[56:59], v[34:37], v[112:127]
    v_rcp_f32 v132, v132
    v_rcp_f32 v133, v133
    v_rcp_f32 v134, v134
    v_rcp_f32 v135, v135
    v_mfma_f32_32x32x16_bf16 v[112:127], v[60:63], v[38:41], v[112:127]
    v_rcp_f32 v136, v136
    v_rcp_f32 v137, v137
    v_rcp_f32 v138, v138
    v_rcp_f32 v139, v139
    v_mfma_f32_32x32x16_bf16 v[80:95], v[72:75], v[64:67], v[80:95]
    v_rcp_f32 v140, v140
    v_rcp_f32 v141, v141
    v_rcp_f32 v142, v142
    v_rcp_f32 v143, v143
K2_L3:
    v_exp_f32 v144, v112
    v_exp_f32 v145, v113
    v_mfma_f32_32x32x16_bf16 v[80:95], v[76:79], v[68:71], v[80:95]
    v_exp_f32 v146, v114
    v_exp_f32 v147, v115
    v_exp_f32 v148, v116
    v_exp_f32 v149, v117
    v_exp_f32 v150, v118
    v_exp_f32 v151, v119
    s_waitcnt vmcnt(2)
    ds_read_b128 v[52:55], v2 offset:0
    ds_read_b128 v[56:59], v3 offset:0
    ds_read_b128 v[64:67], v7 offset:6144
    ds_read_b128 v[68:71], v7 offset:7168
    ds_read_b64_tr_b16 v[60:61], v4 offset:8192
    ds_read_b64 v[62:63], v5 offset:2048
    ds_read_u16 v8, v6 offset:3072
    ds_read_u16 v10, v6 offset:3328
    v_exp_f32 v152, v120
    v_exp_f32 v153, v121
    v_exp_f32 v154, v122
    v_exp_f32 v155, v123
    v_exp_f32 v156, v124
    v_exp_f32 v157, v125
    v_exp_f32 v158, v126
    v_exp_f32 v159, v127
    v_pk_mul_f32 v[128:129], v[128:129], v[96:97]
    v_pk_mul_f32 v[130:131], v[130:131], v[98:99]
    v_pk_mul_f32 v[132:133], v[132:133], v[100:101]
    v_pk_mul_f32 v[134:135], v[134:135], v[102:103]
    v_pk_mul_f32 v[136:137], v[136:137], v[104:105]
    v_pk_mul_f32 v[138:139], v[138:139], v[106:107]
    v_pk_mul_f32 v[140:141], v[140:141], v[108:109]
    v_pk_mul_f32 v[142:143], v[142:143], v[110:111]
    v_mfma_f32_32x32x16_bf16 v[144:159], v[26:29], v[26:29], v[144:159]
    v_cvt_pk_bf16_f32 v72, v128, v129
    v_cvt_pk_bf16_f32 v73, v130, v131
    v_cvt_pk_bf16_f32 v74, v132, v133
    v_cvt_pk_bf16_f32 v75, v134, v135
    v_cvt_pk_bf16_f32 v76, v136, v137
    v_cvt_pk_bf16_f32 v77, v138, v139
    v_cvt_pk_bf16_f32 v78, v140, v141
    v_cvt_pk_bf16_f32 v79, v142, v143
    s_waitcnt lgkmcnt(0)
    s_sub_u32 s12, s12, 1
    s_cbranch_scc1 K2_EV3
K2_BK3:
    buffer_load_dwordx4 v[8:9], s[40:43], s44 idxen offen offset:0 lds
    buffer_load_dwordx4 v[10:11], s[40:43], s45 idxen offen offset:1024 lds
    v_mfma_f32_32x32x16_bf16 v[96:111], v[52:55], v[30:33], 0
    v_rcp_f32 v144, v144
    v_rcp_f32 v145, v145
    v_rcp_f32 v146, v146
    v_rcp_f32 v147, v147
    v_mfma_f32_32x32x16_bf16 v[96:111], v[56:59], v[34:37], v[96:111]
    v_rcp_f32 v148, v148
    v_rcp_f32 v149, v149
    v_rcp_f32 v150, v150
    v_rcp_f32 v151, v151
    v_mfma_f32_32x32x16_bf16 v[96:111], v[60:63], v[38:41], v[96:111]
    v_rcp_f32 v152, v152
    v_rcp_f32 v153, v153
    v_rcp_f32 v154, v154
    v_rcp_f32 v155, v155
    v_mfma_f32_32x32x16_bf16 v[80:95], v[72:75], v[64:67], v[80:95]
    v_rcp_f32 v156, v156
    v_rcp_f32 v157, v157
    v_rcp_f32 v158, v158
    v_rcp_f32 v159, v159
K2_L4:
    v_add_u32 v4, 8192, v4
    v_add_u32 v7, 8192, v7
    v_add_u32 v5, 2048, v5
    v_add_u32 v6, 2048, v6
    s_add_u32 s83, s83, 4
    s_branch K2_LOOP
K2_EVF:
    s_bitcmp1_b64 s[48:49], s15
    s_cbranch_scc0 K2_EVBF
    s_cbranch_vccnz K2_SWF
    s_set_gpr_idx_on s52, gpr_idx(SRC0)
    v_mov_b32 v38, v42
    v_mov_b32 v39, v43
    s_set_gpr_idx_off
    s_mov_b32 m0, s59
    s_lshr_b64 s[52:53], s[52:53], 8
K2_EVBF:
    s_bitset0_b64 s[20:21], s15
    s_not_b32 s12, s15
    s_ff1_i32_b64 s15, s[20:21]
    s_add_u32 s12, s12, s15
    s_cmp_ge_i32 s15, 0
    s_cbranch_scc1 K2_BKF
    v_add_u32 v8, 2048, v7
    s_branch K2_EXIT0
K2_EV0:
    s_bitcmp1_b64 s[22:23], s15
    s_cbranch_scc0 K2_EVA0
    s_cbranch_vccnz K2_SF0
    s_call_b64 s[30:31], K2_FLUSH
K2_EVA0:
    s_bitcmp1_b64 s[48:49], s15
    s_cbranch_scc0 K2_EVB0
    s_cbranch_vccnz K2_SW0
    s_set_gpr_idx_on s52, gpr_idx(SRC0)
    v_mov_b32 v38, v42
    v_mov_b32 v39, v43
    s_set_gpr_idx_off
    s_mov_b32 m0, s59
    s_lshr_b64 s[52:53], s[52:53], 8
K2_EVB0:
    s_bitset0_b64 s[20:21], s15
    s_not_b32 s12, s15
    s_ff1_i32_b64 s15, s[20:21]
    s_add_u32 s12, s12, s15
    s_cmp_ge_i32 s15, 0
    s_cbranch_scc1 K2_BK0
    v_add_u32 v8, 2048, v7
    s_branch K2_EXIT0
K2_EV1:
    s_bitcmp1_b64 s[22:23], s15
    s_cbranch_scc0 K2_EVA1
    s_cbranch_vccnz K2_SF1
    s_call_b64 s[30:31], K2_FLUSH
K2_EVA1:
    s_bitcmp1_b64 s[48:49], s15
    s_cbranch_scc0 K2_EVB1
    s_cbranch_vccnz K2_SW1
    s_set_gpr_idx_on s52, gpr_idx(SRC0)
    v_mov_b32 v38, v42
    v_mov_b32 v39, v43
    s_set_gpr_idx_off
    s_mov_b32 m0, s59
    s_lshr_b64 s[52:53], s[52:53], 8
K2_EVB1:
    s_bitset0_b64 s[20:21], s15
    s_not_b32 s12, s15
    s_ff1_i32_b64 s15, s[20:21]
    s_add_u32 s12, s12, s15
    s_cmp_ge_i32 s15, 0
    s_cbranch_scc1 K2_BK1
    v_add_u32 v8, 4096, v7
    s_branch K2_EXIT1
K2_EV2:
    s_bitcmp1_b64 s[22:23], s15
    s_cbranch_scc0 K2_EVA2
    s_cbranch_vccnz K2_SF2
    s_call_b64 s[30:31], K2_FLUSH
K2_EVA2:
    s_bitcmp1_b64 s[48:49], s15
    s_cbranch_scc0 K2_EVB2
    s_cbranch_vccnz K2_SW2
    s_set_gpr_idx_on s52, gpr_idx(SRC0)
    v_mov_b32 v38, v42
    v_mov_b32 v39, v43
    s_set_gpr_idx_off
    s_mov_b32 m0, s59
    s_lshr_b64 s[52:53], s[52:53], 8
K2_EVB2:
    s_bitset0_b64 s[20:21], s15
    s_not_b32 s12, s15
    s_ff1_i32_b64 s15, s[20:21]
    s_add_u32 s12, s12, s15
    s_cmp_ge_i32 s15, 0
    s_cbranch_scc1 K2_BK2
    v_add_u32 v8, 6144, v7
    s_branch K2_EXIT0
K2_EV3:
    s_bitcmp1_b64 s[22:23], s15
    s_cbranch_scc0 K2_EVA3
    s_cbranch_vccnz K2_SF3
    s_call_b64 s[30:31], K2_FLUSH
K2_EVA3:
    s_bitcmp1_b64 s[48:49], s15
    s_cbranch_scc0 K2_EVB3
    s_cbranch_vccnz K2_SW3
    s_set_gpr_idx_on s52, gpr_idx(SRC0)
    v_mov_b32 v38, v42
    v_mov_b32 v39, v43
    s_set_gpr_idx_off
    s_mov_b32 m0, s59
    s_lshr_b64 s[52:53], s[52:53], 8
K2_EVB3:
    s_bitset0_b64 s[20:21], s15
    s_not_b32 s12, s15
    s_ff1_i32_b64 s15, s[20:21]
    s_add_u32 s12, s12, s15
    s_cmp_ge_i32 s15, 0
    s_cbranch_scc1 K2_BK3
    v_add_u32 v8, 8192, v7
K2_EXIT1:
    v_mfma_f32_32x32x16_bf16 v[80:95], v[72:75], v[64:67], v[80:95]
    v_rcp_f32 v144, v144
    v_rcp_f32 v145, v145
    v_rcp_f32 v146, v146
    v_rcp_f32 v147, v147
    v_mfma_f32_32x32x16_bf16 v[80:95], v[76:79], v[68:71], v[80:95]
    ds_read_b128 v[64:67], v8
    ds_read_b128 v[68:71], v8 offset:1024
    s_sub_u32 s58, s5, 1
    s_xor_b32 s58, s58, s61
    s_lshr_b32 s57, s50, 3
    s_bitset0_b32 s58, s57
    s_lshl2_add_u32 s62, s60, s62
    s_movk_i32 s24, 0xff
    s_movk_i32 s25, 0xff
    buffer_load_dwordx4 v[240:243], v1, s[36:39], s67 offen offset:0
    buffer_load_dwordx4 v[244:247], v1, s[36:39], s67 offen offset:1024
    buffer_load_dwordx4 v[248:251], v1, s[36:39], s67 offen offset:2048
    buffer_load_dwordx4 v[252:255], v1, s[36:39], s67 offen offset:3072
    v_rcp_f32 v148, v148
    v_rcp_f32 v149, v149
    v_mfma_f32_16x16x32_bf16 v[96:99], v[200:203], v[160:163], 0
    v_rcp_f32 v150, v150
    v_mfma_f32_16x16x32_bf16 v[100:103], v[200:203], v[168:171], 0
    v_rcp_f32 v151, v151
    v_mfma_f32_16x16x32_bf16 v[104:107], v[200:203], v[176:179], 0
    v_rcp_f32 v152, v152
    v_mfma_f32_16x16x32_bf16 v[108:111], v[200:203], v[184:187], 0
    v_rcp_f32 v153, v153
    v_mfma_f32_16x16x32_bf16 v[128:131], v[200:203], v[192:195], 0
    v_rcp_f32 v154, v154
    v_mfma_f32_16x16x32_bf16 v[96:99], v[204:207], v[164:167], v[96:99]
    v_rcp_f32 v155, v155
    v_mfma_f32_16x16x32_bf16 v[100:103], v[204:207], v[172:175], v[100:103]
    v_rcp_f32 v156, v156
    v_mfma_f32_16x16x32_bf16 v[104:107], v[204:207], v[180:183], v[104:107]
    v_rcp_f32 v157, v157
    v_mfma_f32_16x16x32_bf16 v[108:111], v[204:207], v[188:191], v[108:111]
    v_rcp_f32 v158, v158
    v_mfma_f32_16x16x32_bf16 v[128:131], v[204:207], v[196:199], v[128:131]
    v_rcp_f32 v159, v159
    v_pk_mul_f32 v[144:145], v[144:145], v[112:113]
    v_pk_mul_f32 v[146:147], v[146:147], v[114:115]
    v_pk_mul_f32 v[148:149], v[148:149], v[116:117]
    v_pk_mul_f32 v[150:151], v[150:151], v[118:119]
    v_pk_mul_f32 v[152:153], v[152:153], v[120:121]
    v_pk_mul_f32 v[154:155], v[154:155], v[122:123]
    v_pk_mul_f32 v[156:157], v[156:157], v[124:125]
    v_pk_mul_f32 v[158:159], v[158:159], v[126:127]
    v_mov_b32 v52, v96
    v_mov_b32 v53, v100
    v_mov_b32 v54, v104
    v_mov_b32 v55, v108
    v_mov_b32 v56, v128
    v_cvt_pk_bf16_f32 v72, v144, v145
    v_cvt_pk_bf16_f32 v73, v146, v147
    v_cvt_pk_bf16_f32 v74, v148, v149
    v_cvt_pk_bf16_f32 v75, v150, v151
    v_cvt_pk_bf16_f32 v76, v152, v153
    v_cvt_pk_bf16_f32 v77, v154, v155
    v_cvt_pk_bf16_f32 v78, v156, v157
    v_cvt_pk_bf16_f32 v79, v158, v159
    s_branch K2_EXITC
K2_EXIT0:
    v_mfma_f32_32x32x16_bf16 v[80:95], v[72:75], v[64:67], v[80:95]
    v_rcp_f32 v128, v128
    v_rcp_f32 v129, v129
    v_rcp_f32 v130, v130
    v_rcp_f32 v131, v131
    v_mfma_f32_32x32x16_bf16 v[80:95], v[76:79], v[68:71], v[80:95]
    ds_read_b128 v[64:67], v8
    ds_read_b128 v[68:71], v8 offset:1024
    s_sub_u32 s58, s5, 1
    s_xor_b32 s58, s58, s61
    s_lshr_b32 s57, s50, 3
    s_bitset0_b32 s58, s57
    s_lshl2_add_u32 s62, s60, s62
    s_movk_i32 s24, 0xff
    s_movk_i32 s25, 0xff
    buffer_load_dwordx4 v[240:243], v1, s[36:39], s67 offen offset:0
    buffer_load_dwordx4 v[244:247], v1, s[36:39], s67 offen offset:1024
    buffer_load_dwordx4 v[248:251], v1, s[36:39], s67 offen offset:2048
    buffer_load_dwordx4 v[252:255], v1, s[36:39], s67 offen offset:3072
    v_rcp_f32 v132, v132
    v_rcp_f32 v133, v133
    v_mfma_f32_16x16x32_bf16 v[112:115], v[200:203], v[160:163], 0
    v_rcp_f32 v134, v134
    v_mfma_f32_16x16x32_bf16 v[116:119], v[200:203], v[168:171], 0
    v_rcp_f32 v135, v135
    v_mfma_f32_16x16x32_bf16 v[120:123], v[200:203], v[176:179], 0
    v_rcp_f32 v136, v136
    v_mfma_f32_16x16x32_bf16 v[124:127], v[200:203], v[184:187], 0
    v_rcp_f32 v137, v137
    v_mfma_f32_16x16x32_bf16 v[144:147], v[200:203], v[192:195], 0
    v_rcp_f32 v138, v138
    v_mfma_f32_16x16x32_bf16 v[112:115], v[204:207], v[164:167], v[112:115]
    v_rcp_f32 v139, v139
    v_mfma_f32_16x16x32_bf16 v[116:119], v[204:207], v[172:175], v[116:119]
    v_rcp_f32 v140, v140
    v_mfma_f32_16x16x32_bf16 v[120:123], v[204:207], v[180:183], v[120:123]
    v_rcp_f32 v141, v141
    v_mfma_f32_16x16x32_bf16 v[124:127], v[204:207], v[188:191], v[124:127]
    v_rcp_f32 v142, v142
    v_mfma_f32_16x16x32_bf16 v[144:147], v[204:207], v[196:199], v[144:147]
    v_rcp_f32 v143, v143
    v_pk_mul_f32 v[128:129], v[128:129], v[96:97]
    v_pk_mul_f32 v[130:131], v[130:131], v[98:99]
    v_pk_mul_f32 v[132:133], v[132:133], v[100:101]
    v_pk_mul_f32 v[134:135], v[134:135], v[102:103]
    v_pk_mul_f32 v[136:137], v[136:137], v[104:105]
    v_pk_mul_f32 v[138:139], v[138:139], v[106:107]
    v_pk_mul_f32 v[140:141], v[140:141], v[108:109]
    v_pk_mul_f32 v[142:143], v[142:143], v[110:111]
    v_mov_b32 v52, v112
    v_mov_b32 v53, v116
    v_mov_b32 v54, v120
    v_mov_b32 v55, v124
    v_mov_b32 v56, v144
    v_cvt_pk_bf16_f32 v72, v128, v129
    v_cvt_pk_bf16_f32 v73, v130, v131
    v_cvt_pk_bf16_f32 v74, v132, v133
    v_cvt_pk_bf16_f32 v75, v134, v135
    v_cvt_pk_bf16_f32 v76, v136, v137
    v_cvt_pk_bf16_f32 v77, v138, v139
    v_cvt_pk_bf16_f32 v78, v140, v141
    v_cvt_pk_bf16_f32 v79, v142, v143
K2_EXITC:
    s_bitcmp1_b64 s[22:23], s13
    s_cbranch_scc1 K2_EXFL
K2_EXF:
    s_cmp_lg_u32 s62, 4
    s_waitcnt lgkmcnt(0)
    v_mfma_f32_32x32x16_bf16 v[80:95], v[72:75], v[64:67], v[80:95]
    s_cbranch_scc1 K2_NOIMP
    v_lshl_add_u32 v238, s4, 10, v1
    v_lshlrev_b32 v239, 2, s4
    ds_read_b32 v230, v239 offset:36896
    ds_read_b128 v[128:131], v238 offset:32768
    ds_read_b128 v[132:135], v238 offset:32896
    ds_read_b128 v[136:139], v238 offset:33024
    ds_read_b128 v[140:143], v238 offset:33152
K2_NOIMP:
    v_mfma_f32_32x32x16_bf16 v[80:95], v[76:79], v[68:71], v[80:95]
    s_cmp_eq_u32 s60, 0
    s_cbranch_scc1 K2_ENDROUND
K2_FIN:
    s_and_b32 s56, s50, 0xff
    s_lshl_b32 s57, s56, 6
    s_lshr_b32 s56, s56, 3
    v_add_u32 v8, s57, v14
    v_add_u32 v10, s57, v15
    s_bitset0_b32 s58, s56
    v_lshlrev_b32 v100, 16, v220
    v_and_b32 v101, 0xffff0000, v220
    v_lshlrev_b32 v102, 16, v221
    v_and_b32 v103, 0xffff0000, v221
    v_lshlrev_b32 v104, 16, v222
    v_and_b32 v105, 0xffff0000, v222
    v_lshlrev_b32 v106, 16, v223
    v_and_b32 v107, 0xffff0000, v223
    v_lshlrev_b32 v108, 16, v224
    v_and_b32 v109, 0xffff0000, v224
    v_lshlrev_b32 v110, 16, v225
    v_and_b32 v111, 0xffff0000, v225
    s_cmp_lg_u32 s62, 4
    s_cbranch_scc1 K2_FN
K2_FLM:
    s_waitcnt lgkmcnt(0)
    v_readfirstlane_b32 s57, v230
    s_mov_b64 exec, s[24:25]
    s_nop 2
    s_cmp_eq_u32 s57, 0
    s_cbranch_scc1 K2_FLR
    v_pk_add_f32 v[80:81], v[80:81], v[128:129]
    v_pk_add_f32 v[82:83], v[82:83], v[130:131]
    v_pk_add_f32 v[84:85], v[84:85], v[132:133]
    v_pk_add_f32 v[86:87], v[86:87], v[134:135]
    v_pk_add_f32 v[88:89], v[88:89], v[136:137]
    v_pk_add_f32 v[90:91], v[90:91], v[138:139]
    v_pk_add_f32 v[92:93], v[92:93], v[140:141]
    v_pk_add_f32 v[94:95], v[94:95], v[142:143]
    s_mov_b64 exec, -1
K2_FN:
    s_cmp_eq_u32 s62, 5
    s_cbranch_scc1 K2_FEXP
K2_FD:
    v_cvt_pk_bf16_f32 v144, v80, v81
    v_cvt_pk_bf16_f32 v145, v82, v83
    v_cvt_pk_bf16_f32 v146, v84, v85
    v_cvt_pk_bf16_f32 v147, v86, v87
    v_cvt_pk_bf16_f32 v148, v88, v89
    v_cvt_pk_bf16_f32 v149, v90, v91
    v_cvt_pk_bf16_f32 v150, v92, v93
    v_cvt_pk_bf16_f32 v151, v94, v95
    v_mfma_f32_16x16x32_bf16 v[60:63], v[200:203], v[144:147], 0
    s_mov_b64 exec, s[24:25]
    v_mfma_f32_16x16x32_bf16 v[60:63], v[204:207], v[148:151], v[60:63]
    s_waitcnt vmcnt(4)
    ds_write_b128 v8, v[144:147]
    ds_write_b128 v10, v[148:151]
    s_and_b32 s58, s58, 31
    s_cbranch_scc0 K2_NS4
    s_bitcmp1_b32 s58, 0
    s_cbranch_scc0 K2_NS0
    ds_write_b128 v14, v[160:163] offset:0
    ds_write_b128 v15, v[164:167] offset:0
K2_NS0:
    s_bitcmp1_b32 s58, 1
    s_cbranch_scc0 K2_NS1
    ds_write_b128 v14, v[168:171] offset:512
    ds_write_b128 v15, v[172:175] offset:512
K2_NS1:
    s_bitcmp1_b32 s58, 2
    s_cbranch_scc0 K2_NS2
    ds_write_b128 v14, v[176:179] offset:1024
    ds_write_b128 v15, v[180:183] offset:1024
K2_NS2:
    s_bitcmp1_b32 s58, 3
    s_cbranch_scc0 K2_NS3
    ds_write_b128 v14, v[184:187] offset:1536
    ds_write_b128 v15, v[188:191] offset:1536
K2_NS3:
    s_bitcmp1_b32 s58, 4
    s_cbranch_scc0 K2_NS4
    ds_write_b128 v14, v[192:195] offset:2048
    ds_write_b128 v15, v[196:199] offset:2048
K2_NS4:
    s_mov_b32 exec_lo, -1
    s_mov_b32 exec_hi, 0
    s_set_gpr_idx_on s56, gpr_idx(DST)
    v_mov_b32 v52, v60
    s_set_gpr_idx_off
    ds_write2_b32 v24, v52, v53 offset0:0 offset1:32
    ds_write2_b32 v24, v54, v55 offset0:64 offset1:96
    ds_write_b32 v24, v56 offset:512
    s_mov_b32 exec_hi, -1
    s_waitcnt lgkmcnt(0)
    s_barrier
    ds_read_b128 v[32:35], v18 offset:0
    ds_read_b128 v[36:39], v18 offset:4096
    ds_read_b128 v[40:43], v18 offset:8192
    ds_read_b128 v[44:47], v18 offset:12288
    ds_read_b128 v[48:51], v19 offset:1024
    ds_read_b128 v[52:55], v19 offset:5120
    ds_read_b128 v[56:59], v19 offset:9216
    ds_read_b128 v[60:63], v19 offset:13312
    ds_read_b128 v[64:67], v20 offset:2048
    ds_read_b128 v[68:71], v20 offset:6144
    ds_read_b128 v[72:75], v20 offset:10240
    ds_read_b128 v[76:79], v20 offset:14336
    s_mov_b32 s24, 0xbfb8aa3b
    s_mov_b32 s25, 0xbfb8aa3b
    s_add_u32 s13, s69, 4096
    s_add_u32 s12, s69, 8192
    s_cmpk_lt_u32 s3, 320
    s_waitcnt lgkmcnt(11) vmcnt(3)
    v_mfma_f32_16x16x32_bf16 v[208:211], v[240:243], v[32:35], v[208:211]
    s_waitcnt lgkmcnt(10) vmcnt(2)
    v_mfma_f32_16x16x32_bf16 v[208:211], v[244:247], v[36:39], v[208:211]
    s_waitcnt lgkmcnt(9) vmcnt(1)
    v_mfma_f32_16x16x32_bf16 v[208:211], v[248:251], v[40:43], v[208:211]
    s_waitcnt lgkmcnt(8) vmcnt(0)
    v_mfma_f32_16x16x32_bf16 v[208:211], v[252:255], v[44:47], v[208:211]
    s_waitcnt lgkmcnt(7)
    v_mfma_f32_16x16x32_bf16 v[212:215], v[240:243], v[48:51], v[212:215]
    s_waitcnt lgkmcnt(6)
    v_mfma_f32_16x16x32_bf16 v[212:215], v[244:247], v[52:55], v[212:215]
    s_waitcnt lgkmcnt(5)
    v_mfma_f32_16x16x32_bf16 v[212:215], v[248:251], v[56:59], v[212:215]
    s_waitcnt lgkmcnt(4)
    v_mfma_f32_16x16x32_bf16 v[212:215], v[252:255], v[60:63], v[212:215]
    v_exp_f32 v112, v208
    v_exp_f32 v113, v209
    v_exp_f32 v114, v210
    v_exp_f32 v115, v211
    s_waitcnt lgkmcnt(3)
    v_mfma_f32_16x16x32_bf16 v[216:219], v[240:243], v[64:67], v[216:219]
    s_waitcnt lgkmcnt(2)
    v_mfma_f32_16x16x32_bf16 v[216:219], v[244:247], v[68:71], v[216:219]
    s_waitcnt lgkmcnt(1)
    v_mfma_f32_16x16x32_bf16 v[216:219], v[248:251], v[72:75], v[216:219]
    s_waitcnt lgkmcnt(0)
    v_mfma_f32_16x16x32_bf16 v[216:219], v[252:255], v[76:79], v[216:219]
    s_cbranch_scc0 K2_NOPR
    ds_read2st64_b32 v[88:89], v16 offset0:0 offset1:16
    ds_read2st64_b32 v[90:91], v16 offset0:32 offset1:48
    ds_read2st64_b32 v[92:93], v16 offset0:64 offset1:80
    ds_read2st64_b32 v[94:95], v16 offset0:96 offset1:112
K2_NOPR:
    v_exp_f32 v116, v212
    v_exp_f32 v117, v213
    v_exp_f32 v118, v214
    v_exp_f32 v119, v215
    v_pk_fma_f32 v[112:113], v[112:113], s[24:25], s[24:25]
    v_pk_fma_f32 v[114:115], v[114:115], s[24:25], s[24:25]
    v_rcp_f32 v112, v112
    v_rcp_f32 v113, v113
    v_rcp_f32 v114, v114
    v_rcp_f32 v115, v115
    v_pk_fma_f32 v[116:117], v[116:117], s[24:25], s[24:25]
    v_pk_fma_f32 v[118:119], v[118:119], s[24:25], s[24:25]
    v_exp_f32 v120, v216
    v_exp_f32 v121, v217
    v_exp_f32 v122, v218
    v_exp_f32 v123, v219
    v_pk_fma_f32 v[100:101], v[112:113], v[208:209], v[100:101]
    v_pk_fma_f32 v[102:103], v[114:115], v[210:211], v[102:103]
    v_cvt_pk_bf16_f32 v80, v100, v101
    v_cvt_pk_bf16_f32 v81, v102, v103
    buffer_store_dwordx2 v[80:81], v12, s[32:35], s69 offen
    v_rcp_f32 v116, v116
    v_rcp_f32 v117, v117
    v_rcp_f32 v118, v118
    v_rcp_f32 v119, v119
    v_pk_fma_f32 v[120:121], v[120:121], s[24:25], s[24:25]
    v_pk_fma_f32 v[122:123], v[122:123], s[24:25], s[24:25]
    s_cbranch_scc0 K2_NOPOS
    s_waitcnt lgkmcnt(0)
    v_pk_add_f32 v[88:89], v[88:89], v[90:91]
    v_pk_add_f32 v[92:93], v[92:93], v[94:95]
    v_pk_add_f32 v[88:89], v[88:89], v[92:93]
    v_add_f32 v96, v88, v89
    v_fmac_f32 v21, 0xbf317218, v96
    v_cvt_pk_bf16_f32 v21, v21, v21
    s_mov_b64 exec, 0xffffff
    buffer_store_short v21, v22, s[32:35], s68 offen
    s_mov_b64 exec, -1
K2_NOPOS:
    v_rcp_f32 v120, v120
    v_rcp_f32 v121, v121
    v_rcp_f32 v122, v122
    v_rcp_f32 v123, v123
    v_pk_fma_f32 v[104:105], v[116:117], v[212:213], v[104:105]
    v_pk_fma_f32 v[106:107], v[118:119], v[214:215], v[106:107]
    v_cvt_pk_bf16_f32 v82, v104, v105
    v_cvt_pk_bf16_f32 v83, v106, v107
    buffer_store_dwordx2 v[82:83], v12, s[32:35], s13 offen
    v_pk_fma_f32 v[108:109], v[120:121], v[216:217], v[108:109]
    v_pk_fma_f32 v[110:111], v[122:123], v[218:219], v[110:111]
    v_cvt_pk_bf16_f32 v84, v108, v109
    v_cvt_pk_bf16_f32 v85, v110, v111
    s_mov_b32 exec_lo, 0x00ff00ff
    s_mov_b32 exec_hi, 0x00ff00ff
    buffer_store_dwordx2 v[84:85], v12, s[32:35], s12 offen
K2_END:
    s_endpgm
K2_FLUSH:
    s_and_b32 s56, s62, 5
    s_cbranch_scc1 K2_FLX
K2_FLN:
    s_set_gpr_idx_on s50, gpr_idx(DST)
    v_cvt_pk_bf16_f32 v160, v80, v81
    v_cvt_pk_bf16_f32 v161, v82, v83
    v_cvt_pk_bf16_f32 v162, v84, v85
    v_cvt_pk_bf16_f32 v163, v86, v87
    v_cvt_pk_bf16_f32 v164, v88, v89
    v_cvt_pk_bf16_f32 v165, v90, v91
    v_cvt_pk_bf16_f32 v166, v92, v93
    v_cvt_pk_bf16_f32 v167, v94, v95
K2_FLO:
    s_set_gpr_idx_off
    s_mov_b32 m0, s59
    s_lshr_b64 s[50:51], s[50:51], 8
    s_cbranch_vccnz K2_FLQ
    v_mov_b64 v[80:81], 0
    v_mov_b64 v[82:83], 0
    v_mov_b64 v[84:85], 0
    v_mov_b64 v[86:87], 0
    v_mov_b64 v[88:89], 0
    v_mov_b64 v[90:91], 0
    v_mov_b64 v[92:93], 0
    v_mov_b64 v[94:95], 0
K2_FLQ:
    s_setpc_b64 s[30:31]
K2_SWF:
    v_add_u32 v4, 2048, v4
    ds_read_b64_tr_b16 v[240:241], v4 offset:2048
    s_bitset0_b64 s[20:21], s15
    s_not_b32 s12, s15
    s_ff1_i32_b64 s15, s[20:21]
    s_add_u32 s12, s12, s15
    buffer_load_dwordx4 v[8:9], s[40:43], s46 idxen offen offset:2048 lds
    buffer_load_dwordx4 v[10:11], s[40:43], s47 idxen offen offset:3072 lds
    v_mfma_f32_32x32x16_bf16 v[112:127], v[52:55], v[30:33], 0
    v_rcp_f32 v128, v128
    v_rcp_f32 v129, v129
    v_rcp_f32 v130, v130
    v_mfma_f32_32x32x16_bf16 v[112:127], v[56:59], v[34:37], v[112:127]
    v_rcp_f32 v131, v131
    v_rcp_f32 v132, v132
    v_rcp_f32 v133, v133
    v_mfma_f32_32x32x16_bf16 v[112:127], v[60:63], v[38:41], v[112:127]
    v_rcp_f32 v134, v134
    v_rcp_f32 v135, v135
    s_set_gpr_idx_on s52, gpr_idx(SRC0)
    v_mov_b32 v38, v42
    v_mov_b32 v39, v43
    s_set_gpr_idx_off
    s_mov_b32 m0, s59
    s_lshr_b64 s[52:53], s[52:53], 8
    v_rcp_f32 v136, v136
    s_waitcnt lgkmcnt(0)
    v_mfma_f32_32x32x16_bf16 v[112:127], v[240:243], v[38:41], v[112:127]
    v_rcp_f32 v137, v137
    v_rcp_f32 v138, v138
    v_rcp_f32 v139, v139
    s_nop 1
    v_rcp_f32 v140, v140
    v_rcp_f32 v141, v141
    v_rcp_f32 v142, v142
    v_rcp_f32 v143, v143
    v_exp_f32 v144, v112
    v_exp_f32 v145, v113
    s_branch K2_L1B
K2_SW0:
    v_add_u32 v4, 2048, v4
    ds_read_b64_tr_b16 v[240:241], v4 offset:2048
    s_bitset0_b64 s[20:21], s15
    s_not_b32 s12, s15
    s_ff1_i32_b64 s15, s[20:21]
    s_add_u32 s12, s12, s15
    buffer_load_dwordx4 v[8:9], s[40:43], s46 idxen offen offset:2048 lds
    buffer_load_dwordx4 v[10:11], s[40:43], s47 idxen offen offset:3072 lds
    v_mfma_f32_32x32x16_bf16 v[112:127], v[52:55], v[30:33], 0
    v_rcp_f32 v128, v128
    v_rcp_f32 v129, v129
    v_rcp_f32 v130, v130
    v_mfma_f32_32x32x16_bf16 v[112:127], v[56:59], v[34:37], v[112:127]
    v_rcp_f32 v131, v131
    v_rcp_f32 v132, v132
    v_rcp_f32 v133, v133
    v_mfma_f32_32x32x16_bf16 v[112:127], v[60:63], v[38:41], v[112:127]
    v_rcp_f32 v134, v134
    v_rcp_f32 v135, v135
    s_set_gpr_idx_on s52, gpr_idx(SRC0)
    v_mov_b32 v38, v42
    v_mov_b32 v39, v43
    s_set_gpr_idx_off
    s_mov_b32 m0, s59
    s_lshr_b64 s[52:53], s[52:53], 8
    v_rcp_f32 v136, v136
    s_waitcnt lgkmcnt(0)
    v_mfma_f32_32x32x16_bf16 v[112:127], v[240:243], v[38:41], v[112:127]
    v_rcp_f32 v137, v137
    v_rcp_f32 v138, v138
    v_rcp_f32 v139, v139
    v_mfma_f32_32x32x16_bf16 v[80:95], v[72:75], v[64:67], v[80:95]
    v_rcp_f32 v140, v140
    v_rcp_f32 v141, v141
    v_rcp_f32 v142, v142
    v_rcp_f32 v143, v143
    s_branch K2_L1
K2_SF0:
    v_mfma_f32_32x32x16_bf16 v[80:95], v[72:75], v[64:67], v[80:95]
    v_add_u32 v7, 2048, v7
    buffer_load_dwordx4 v[8:9], s[40:43], s46 idxen offen offset:2048 lds
    buffer_load_dwordx4 v[10:11], s[40:43], s47 idxen offen offset:3072 lds
    v_mfma_f32_32x32x16_bf16 v[112:127], v[52:55], v[30:33], 0
    s_bitset0_b64 s[20:21], s15
    s_not_b32 s12, s15
    s_ff1_i32_b64 s15, s[20:21]
    s_add_u32 s12, s12, s15
    v_rcp_f32 v128, v128
    v_rcp_f32 v129, v129
    v_rcp_f32 v130, v130
    v_mfma_f32_32x32x16_bf16 v[80:95], v[76:79], v[68:71], v[80:95]
    ds_read_b128 v[64:67], v7 offset:0
    ds_read_b128 v[68:71], v7 offset:1024
    v_rcp_f32 v131, v131
    v_rcp_f32 v132, v132
    v_mfma_f32_32x32x16_bf16 v[112:127], v[56:59], v[34:37], v[112:127]
    v_rcp_f32 v133, v133
    v_rcp_f32 v134, v134
    v_rcp_f32 v135, v135
    v_mfma_f32_32x32x16_bf16 v[112:127], v[60:63], v[38:41], v[112:127]
    v_rcp_f32 v136, v136
    v_rcp_f32 v137, v137
    v_rcp_f32 v138, v138
    v_rcp_f32 v139, v139
    s_call_b64 s[30:31], K2_FLUSH
    s_waitcnt lgkmcnt(0)
    v_mfma_f32_32x32x16_bf16 v[80:95], v[72:75], v[64:67], 0
    v_rcp_f32 v140, v140
    v_rcp_f32 v141, v141
    v_rcp_f32 v142, v142
    v_rcp_f32 v143, v143
    s_branch K2_L1
K2_SW1:
    v_add_u32 v4, 2048, v4
    ds_read_b64_tr_b16 v[240:241], v4 offset:4096
    s_bitset0_b64 s[20:21], s15
    s_not_b32 s12, s15
    s_ff1_i32_b64 s15, s[20:21]
    s_add_u32 s12, s12, s15
    buffer_load_dwordx4 v[8:9], s[40:43], s44 idxen offen offset:0 lds
    buffer_load_dwordx4 v[10:11], s[40:43], s45 idxen offen offset:1024 lds
    v_mfma_f32_32x32x16_bf16 v[96:111], v[52:55], v[30:33], 0
    v_rcp_f32 v144, v144
    v_rcp_f32 v145, v145
    v_rcp_f32 v146, v146
    v_mfma_f32_32x32x16_bf16 v[96:111], v[56:59], v[34:37], v[96:111]
    v_rcp_f32 v147, v147
    v_rcp_f32 v148, v148
    v_rcp_f32 v149, v149
    v_mfma_f32_32x32x16_bf16 v[96:111], v[60:63], v[38:41], v[96:111]
    v_rcp_f32 v150, v150
    v_rcp_f32 v151, v151
    s_set_gpr_idx_on s52, gpr_idx(SRC0)
    v_mov_b32 v38, v42
    v_mov_b32 v39, v43
    s_set_gpr_idx_off
    s_mov_b32 m0, s59
    s_lshr_b64 s[52:53], s[52:53], 8
    v_rcp_f32 v152, v152
    s_waitcnt lgkmcnt(0)
    v_mfma_f32_32x32x16_bf16 v[96:111], v[240:243], v[38:41], v[96:111]
    v_rcp_f32 v153, v153
    v_rcp_f32 v154, v154
    v_rcp_f32 v155, v155
    v_mfma_f32_32x32x16_bf16 v[80:95], v[72:75], v[64:67], v[80:95]
    v_rcp_f32 v156, v156
    v_rcp_f32 v157, v157
    v_rcp_f32 v158, v158
    v_rcp_f32 v159, v159
    s_branch K2_L2
K2_SF1:
    v_mfma_f32_32x32x16_bf16 v[80:95], v[72:75], v[64:67], v[80:95]
    v_add_u32 v7, 2048, v7
    buffer_load_dwordx4 v[8:9], s[40:43], s44 idxen offen offset:0 lds
    buffer_load_dwordx4 v[10:11], s[40:43], s45 idxen offen offset:1024 lds
    v_mfma_f32_32x32x16_bf16 v[96:111], v[52:55], v[30:33], 0
    s_bitset0_b64 s[20:21], s15
    s_not_b32 s12, s15
    s_ff1_i32_b64 s15, s[20:21]
    s_add_u32 s12, s12, s15
    v_rcp_f32 v144, v144
    v_rcp_f32 v145, v145
    v_rcp_f32 v146, v146
    v_mfma_f32_32x32x16_bf16 v[80:95], v[76:79], v[68:71], v[80:95]
    ds_read_b128 v[64:67], v7 offset:2048
    ds_read_b128 v[68:71], v7 offset:3072
    v_rcp_f32 v147, v147
    v_rcp_f32 v148, v148
    v_mfma_f32_32x32x16_bf16 v[96:111], v[56:59], v[34:37], v[96:111]
    v_rcp_f32 v149, v149
    v_rcp_f32 v150, v150
    v_rcp_f32 v151, v151
    v_mfma_f32_32x32x16_bf16 v[96:111], v[60:63], v[38:41], v[96:111]
    v_rcp_f32 v152, v152
    v_rcp_f32 v153, v153
    v_rcp_f32 v154, v154
    v_rcp_f32 v155, v155
    s_call_b64 s[30:31], K2_FLUSH
    s_waitcnt lgkmcnt(0)
    v_mfma_f32_32x32x16_bf16 v[80:95], v[72:75], v[64:67], 0
    v_rcp_f32 v156, v156
    v_rcp_f32 v157, v157
    v_rcp_f32 v158, v158
    v_rcp_f32 v159, v159
    s_branch K2_L2
K2_SW2:
    v_add_u32 v4, 2048, v4
    ds_read_b64_tr_b16 v[240:241], v4 offset:6144
    s_bitset0_b64 s[20:21], s15
    s_not_b32 s12, s15
    s_ff1_i32_b64 s15, s[20:21]
    s_add_u32 s12, s12, s15
    buffer_load_dwordx4 v[8:9], s[40:43], s46 idxen offen offset:2048 lds
    buffer_load_dwordx4 v[10:11], s[40:43], s47 idxen offen offset:3072 lds
    v_mfma_f32_32x32x16_bf16 v[112:127], v[52:55], v[30:33], 0
    v_rcp_f32 v128, v128
    v_rcp_f32 v129, v129
    v_rcp_f32 v130, v130
    v_mfma_f32_32x32x16_bf16 v[112:127], v[56:59], v[34:37], v[112:127]
    v_rcp_f32 v131, v131
    v_rcp_f32 v132, v132
    v_rcp_f32 v133, v133
    v_mfma_f32_32x32x16_bf16 v[112:127], v[60:63], v[38:41], v[112:127]
    v_rcp_f32 v134, v134
    v_rcp_f32 v135, v135
    s_set_gpr_idx_on s52, gpr_idx(SRC0)
    v_mov_b32 v38, v42
    v_mov_b32 v39, v43
    s_set_gpr_idx_off
    s_mov_b32 m0, s59
    s_lshr_b64 s[52:53], s[52:53], 8
    v_rcp_f32 v136, v136
    s_waitcnt lgkmcnt(0)
    v_mfma_f32_32x32x16_bf16 v[112:127], v[240:243], v[38:41], v[112:127]
    v_rcp_f32 v137, v137
    v_rcp_f32 v138, v138
    v_rcp_f32 v139, v139
    v_mfma_f32_32x32x16_bf16 v[80:95], v[72:75], v[64:67], v[80:95]
    v_rcp_f32 v140, v140
    v_rcp_f32 v141, v141
    v_rcp_f32 v142, v142
    v_rcp_f32 v143, v143
    s_branch K2_L3
K2_SF2:
    v_mfma_f32_32x32x16_bf16 v[80:95], v[72:75], v[64:67], v[80:95]
    v_add_u32 v7, 2048, v7
    buffer_load_dwordx4 v[8:9], s[40:43], s46 idxen offen offset:2048 lds
    buffer_load_dwordx4 v[10:11], s[40:43], s47 idxen offen offset:3072 lds
    v_mfma_f32_32x32x16_bf16 v[112:127], v[52:55], v[30:33], 0
    s_bitset0_b64 s[20:21], s15
    s_not_b32 s12, s15
    s_ff1_i32_b64 s15, s[20:21]
    s_add_u32 s12, s12, s15
    v_rcp_f32 v128, v128
    v_rcp_f32 v129, v129
    v_rcp_f32 v130, v130
    v_mfma_f32_32x32x16_bf16 v[80:95], v[76:79], v[68:71], v[80:95]
    ds_read_b128 v[64:67], v7 offset:4096
    ds_read_b128 v[68:71], v7 offset:5120
    v_rcp_f32 v131, v131
    v_rcp_f32 v132, v132
    v_mfma_f32_32x32x16_bf16 v[112:127], v[56:59], v[34:37], v[112:127]
    v_rcp_f32 v133, v133
    v_rcp_f32 v134, v134
    v_rcp_f32 v135, v135
    v_mfma_f32_32x32x16_bf16 v[112:127], v[60:63], v[38:41], v[112:127]
    v_rcp_f32 v136, v136
    v_rcp_f32 v137, v137
    v_rcp_f32 v138, v138
    v_rcp_f32 v139, v139
    s_call_b64 s[30:31], K2_FLUSH
    s_waitcnt lgkmcnt(0)
    v_mfma_f32_32x32x16_bf16 v[80:95], v[72:75], v[64:67], 0
    v_rcp_f32 v140, v140
    v_rcp_f32 v141, v141
    v_rcp_f32 v142, v142
    v_rcp_f32 v143, v143
    s_branch K2_L3
K2_SW3:
    v_add_u32 v4, 2048, v4
    ds_read_b64_tr_b16 v[240:241], v4 offset:8192
    s_bitset0_b64 s[20:21], s15
    s_not_b32 s12, s15
    s_ff1_i32_b64 s15, s[20:21]
    s_add_u32 s12, s12, s15
    buffer_load_dwordx4 v[8:9], s[40:43], s44 idxen offen offset:0 lds
    buffer_load_dwordx4 v[10:11], s[40:43], s45 idxen offen offset:1024 lds
    v_mfma_f32_32x32x16_bf16 v[96:111], v[52:55], v[30:33], 0
    v_rcp_f32 v144, v144
    v_rcp_f32 v145, v145
    v_rcp_f32 v146, v146
    v_mfma_f32_32x32x16_bf16 v[96:111], v[56:59], v[34:37], v[96:111]
    v_rcp_f32 v147, v147
    v_rcp_f32 v148, v148
    v_rcp_f32 v149, v149
    v_mfma_f32_32x32x16_bf16 v[96:111], v[60:63], v[38:41], v[96:111]
    v_rcp_f32 v150, v150
    v_rcp_f32 v151, v151
    s_set_gpr_idx_on s52, gpr_idx(SRC0)
    v_mov_b32 v38, v42
    v_mov_b32 v39, v43
    s_set_gpr_idx_off
    s_mov_b32 m0, s59
    s_lshr_b64 s[52:53], s[52:53], 8
    v_rcp_f32 v152, v152
    s_waitcnt lgkmcnt(0)
    v_mfma_f32_32x32x16_bf16 v[96:111], v[240:243], v[38:41], v[96:111]
    v_rcp_f32 v153, v153
    v_rcp_f32 v154, v154
    v_rcp_f32 v155, v155
    v_mfma_f32_32x32x16_bf16 v[80:95], v[72:75], v[64:67], v[80:95]
    v_rcp_f32 v156, v156
    v_rcp_f32 v157, v157
    v_rcp_f32 v158, v158
    v_rcp_f32 v159, v159
    s_branch K2_L4
K2_SF3:
    v_mfma_f32_32x32x16_bf16 v[80:95], v[72:75], v[64:67], v[80:95]
    v_add_u32 v7, 2048, v7
    buffer_load_dwordx4 v[8:9], s[40:43], s44 idxen offen offset:0 lds
    buffer_load_dwordx4 v[10:11], s[40:43], s45 idxen offen offset:1024 lds
    v_mfma_f32_32x32x16_bf16 v[96:111], v[52:55], v[30:33], 0
    s_bitset0_b64 s[20:21], s15
    s_not_b32 s12, s15
    s_ff1_i32_b64 s15, s[20:21]
    s_add_u32 s12, s12, s15
    v_rcp_f32 v144, v144
    v_rcp_f32 v145, v145
    v_rcp_f32 v146, v146
    v_mfma_f32_32x32x16_bf16 v[80:95], v[76:79], v[68:71], v[80:95]
    ds_read_b128 v[64:67], v7 offset:6144
    ds_read_b128 v[68:71], v7 offset:7168
    v_rcp_f32 v147, v147
    v_rcp_f32 v148, v148
    v_mfma_f32_32x32x16_bf16 v[96:111], v[56:59], v[34:37], v[96:111]
    v_rcp_f32 v149, v149
    v_rcp_f32 v150, v150
    v_rcp_f32 v151, v151
    v_mfma_f32_32x32x16_bf16 v[96:111], v[60:63], v[38:41], v[96:111]
    v_rcp_f32 v152, v152
    v_rcp_f32 v153, v153
    v_rcp_f32 v154, v154
    v_rcp_f32 v155, v155
    s_call_b64 s[30:31], K2_FLUSH
    s_waitcnt lgkmcnt(0)
    v_mfma_f32_32x32x16_bf16 v[80:95], v[72:75], v[64:67], 0
    v_rcp_f32 v156, v156
    v_rcp_f32 v157, v157
    v_rcp_f32 v158, v158
    v_rcp_f32 v159, v159
    s_branch K2_L4
K2_FLR:
    ds_read_b32 v230, v239 offset:36896
    ds_read_b128 v[128:131], v238 offset:32768
    ds_read_b128 v[132:135], v238 offset:32896
    ds_read_b128 v[136:139], v238 offset:33024
    ds_read_b128 v[140:143], v238 offset:33152
    s_branch K2_FLM
K2_FLX:
    s_bitcmp0_b32 s62, 0
    s_cbranch_scc1 K2_FLD
    s_xor_b32 s62, s62, 3
    v_lshl_add_u32 v238, s4, 10, v1
    v_lshlrev_b32 v239, 2, s4
    v_mov_b32 v230, 1
    s_mov_b32 exec_lo, 0xff
    s_mov_b32 exec_hi, 0xff
    ds_write_b128 v238, v[80:83] offset:32768
    ds_write_b128 v238, v[84:87] offset:32896
    ds_write_b128 v238, v[88:91] offset:33024
    ds_write_b128 v238, v[92:95] offset:33152
    ds_write_b32 v239, v230 offset:36896
    s_mov_b64 exec, -1
    s_bitcmp0_b32 s62, 2
    s_cbranch_scc1 K2_FLN
K2_FLD:
    s_and_b32 s56, s50, 0xff
    s_lshl_b32 s57, s56, 6
    s_lshr_b32 s56, s56, 3
    v_add_u32 v8, s57, v14
    v_add_u32 v10, s57, v15
    v_cvt_pk_bf16_f32 v144, v80, v81
    v_cvt_pk_bf16_f32 v145, v82, v83
    v_cvt_pk_bf16_f32 v146, v84, v85
    v_cvt_pk_bf16_f32 v147, v86, v87
    v_cvt_pk_bf16_f32 v148, v88, v89
    v_cvt_pk_bf16_f32 v149, v90, v91
    v_cvt_pk_bf16_f32 v150, v92, v93
    v_cvt_pk_bf16_f32 v151, v94, v95
    v_mfma_f32_16x16x32_bf16 v[60:63], v[200:203], v[144:147], 0
    s_mov_b64 exec, s[24:25]
    v_mfma_f32_16x16x32_bf16 v[60:63], v[204:207], v[148:151], v[60:63]
    s_waitcnt vmcnt(4)
    ds_write_b128 v8, v[144:147]
    ds_write_b128 v10, v[148:151]
    s_mov_b64 exec, -1
    s_nop 2
    s_set_gpr_idx_on s56, gpr_idx(DST)
    v_mov_b32 v52, v60
    s_branch K2_FLO
F_RL:
    v_mov_b32 v184, 0
    s_mov_b32 s99, 262144
F_RL1:
    global_load_dword v185, v184, s[96:97] sc1
    s_sub_u32 s99, s99, 1
    s_cbranch_scc1 F_RDY
    s_sleep 8
    s_waitcnt vmcnt(0)
    v_cmp_ne_u32 vcc, 0x1, v185
    s_cbranch_vccnz F_RL1
    s_branch F_RDY
K2_PA4:
    v_readlane_b32 s57, v114, 63
    s_nop 1
    v_max_u32_dpp v115, v115, v115 row_shr:1 row_mask:0xf bank_mask:0xf bound_ctrl:0
    s_nop 1
    v_max_u32_dpp v115, v115, v115 row_shr:2 row_mask:0xf bank_mask:0xf bound_ctrl:0
    s_nop 1
    v_max_u32_dpp v115, v115, v115 row_shr:4 row_mask:0xf bank_mask:0xf bound_ctrl:0
    s_nop 1
    v_max_u32_dpp v115, v115, v115 row_shr:8 row_mask:0xf bank_mask:0xf bound_ctrl:0
    s_nop 1
    v_max_u32_dpp v115, v115, v115 row_bcast:15 row_mask:0xa bank_mask:0xf
    s_nop 1
    v_max_u32_dpp v115, v115, v115 row_bcast:31 row_mask:0xc bank_mask:0xf
    v_max_u32 v115, s57, v115
    v_mad_u32_u24 v119, v115, 1, v1
    v_lshrrev_b32 v127, 1, v119
    buffer_load_dwordx2 v[110:111], v127, s[36:39], s66 offen offset:1536
    buffer_load_dwordx2 v[108:109], v127, s[36:39], 0 offen offset:1536
    v_add_u32 v119, 3072, v119
    s_branch K2_PA_DONE
K2_AD4:
    ds_write_b32 v25, v17 offset:1792
    v_lshrrev_b32 v123, 25, v115
    v_lshrrev_b32 v127, 18, v115
    v_lshl_add_u32 v123, v123, 2, s72
    v_and_b32 v127, 0x3c0, v127
    v_and_b32 v72, 28, v123
    v_lshlrev_b32 v59, 9, v72
    ds_read_b32 v123, v123 offset:1280
    v_add_u32 v72, s72, v72
    ds_read_b32 v72, v72 offset:1836
    v_and_b32 v59, s74, v59
    s_mul_i32 s56, s54, -512
    s_waitcnt lgkmcnt(0)
    v_add3_u32 v119, v119, v123, v72
    v_add_u32 v119, s56, v119
    v_min_u32 v119, 24576, v119
    v_lshl_add_u32 v123, v119, 2, v59
    v_bfe_u32 v115, v119, 4, 3
    v_and_b32 v123, 0xfffffe00, v123
    v_lshl_or_b32 v123, v115, 1, v123
    s_branch K2_AD4D
K2_REC4:
    v_lshrrev_b32 v115, 26, v111
    v_and_or_b32 v127, v115, 48, v127
    ds_read_b128 v[72:75], v127 offset:36928
    s_mov_b64 exec, s[18:19]
    v_and_or_b32 v123, v127, s63, v123
    ds_write_b16 v123, v76 offset:62720
    s_mov_b64 exec, -1
    s_waitcnt lgkmcnt(1)
    v_dot2_f32_bf16 v72, v110, s70, v72
    v_dot2_f32_bf16 v73, v110, s71, v73
    v_dot2_f32_bf16 v74, v111, s70, v74
    s_nop 2
    v_cvt_pk_bf16_f32 v73, v72, v73
    v_cvt_pk_bf16_f32 v74, v74, 0
    s_mov_b64 exec, s[18:19]
    v_dot2_f32_bf16 v72, v73, v73, 0
    ds_write_b16 v123, v73 offset:62848
    v_dot2_f32_bf16 v72, v74, v74, v72
    ds_write_b16_d16_hi v123, v73 offset:62976
    ds_write_b16 v123, v74 offset:63104
    s_mov_b64 exec, s[18:19]
    v_mul_f32 v72, 0xbfb8aa3b, v72
    v_cvt_pk_bf16_f32 v72, v72, 0
    v_and_or_b32 v110, v111, s65, v72
    ds_write_b128 v119, v[108:111] offset:37888
    s_mov_b64 exec, -1
    s_cmpk_le_i32 s82, 1024
    s_cbranch_scc1 K2_REC4D
    s_movk_i32 s56, 1024
K2_SHIFT:
    s_cmp_lg_u32 s55, 0
    s_cbranch_scc1 K2_SH1
    v_mov_b32 v235, v232
    v_mov_b32 v236, v233
    v_mov_b32 v237, v234
K2_SH1:
    s_add_u32 s55, s55, s56
    s_sub_u32 s82, s82, s56
    v_subrev_u32 v232, s55, v235
    v_max_i32 v232, s72, v232
    v_subrev_u32 v233, s55, v236
    v_max_i32 v233, s72, v233
    v_subrev_u32 v234, s55, v237
    v_max_i32 v234, s72, v234
    v_lshl_add_u32 v228, s56, 2, v228
    v_lshl_add_u32 v229, s56, 2, v229
    v_mov_b64 v[112:113], 0
    v_mov_b64 v[114:115], 0
    v_add_u32 v116, s72, v1
    ds_write_b128 v116, v[112:115]
    s_waitcnt lgkmcnt(0)
    s_branch K2_BATCH
K2_FEXP:
    s_xor_b32 s62, s62, 3
    v_lshl_add_u32 v238, s4, 10, v1
    v_lshlrev_b32 v239, 2, s4
    v_mov_b32 v230, 1
    s_mov_b32 exec_lo, 0xff
    s_mov_b32 exec_hi, 0xff
    ds_write_b128 v238, v[80:83] offset:32768
    ds_write_b128 v238, v[84:87] offset:32896
    ds_write_b128 v238, v[88:91] offset:33024
    ds_write_b128 v238, v[92:95] offset:33152
    ds_write_b32 v239, v230 offset:36896
    s_mov_b64 exec, -1
    s_branch K2_FD
K2_EXFL:
    s_call_b64 s[30:31], K2_FLUSH
    s_branch K2_EXF
K2_GEN:
    s_mov_b32 s6, 0
    v_readlane_b32 s7, v17, 0
    v_readlane_b32 s8, v17, 1
    v_readlane_b32 s9, v17, 2
    v_readlane_b32 s10, v17, 3
    v_readlane_b32 s11, v17, 4
    s_movk_i32 s73, 127
    s_mov_b32 s74, 0
    v_mov_b64 v[184:185], 0
    v_mov_b64 v[186:187], 0
    v_mov_b64 v[188:189], 0
    v_mov_b64 v[190:191], 0
    v_lshlrev_b32 v238, 4, v0
    ds_write_b128 v238, v[160:163] offset:37888
    ds_write_b128 v238, v[160:163] offset:46080
    ds_write_b128 v238, v[160:163] offset:54272
    s_add_u32 s7, s7, 127
    s_lshr_b32 s7, s7, 7
    s_add_u32 s7, s7, s6
    s_lshl_b32 s56, s7, 9
    v_writelane_b32 v17, s56, 12
    s_add_u32 s8, s8, 127
    s_lshr_b32 s8, s8, 7
    s_add_u32 s8, s8, s7
    s_lshl_b32 s56, s8, 9
    v_writelane_b32 v17, s56, 13
    s_add_u32 s9, s9, 127
    s_lshr_b32 s9, s9, 7
    s_add_u32 s9, s9, s8
    s_lshl_b32 s56, s9, 9
    v_writelane_b32 v17, s56, 14
    s_add_u32 s10, s10, 127
    s_lshr_b32 s10, s10, 7
    s_add_u32 s10, s10, s9
    s_lshl_b32 s56, s10, 9
    v_writelane_b32 v17, s56, 15
    s_add_u32 s11, s11, 127
    s_lshr_b32 s11, s11, 7
    s_add_u32 s11, s11, s10
    s_waitcnt lgkmcnt(0)
    s_barrier
K2_NOTFIRST:
    ds_write2_b32 v231, v226, v227 offset0:0 offset1:4
    ds_write_b32 v25, v17 offset:1792
    v_lshrrev_b32 v120, 25, v112
    v_lshrrev_b32 v124, 18, v112
    v_lshl_add_u32 v120, v120, 2, s72
    v_and_b32 v124, 0x3c0, v124
    v_and_b32 v60, 28, v120
    v_lshlrev_b32 v56, 9, v60
    ds_read_b32 v120, v120 offset:1280
    v_add_u32 v60, s72, v60
    ds_read_b32 v60, v60 offset:1836
    v_and_b32 v56, s74, v56
    v_lshrrev_b32 v121, 25, v113
    v_lshrrev_b32 v125, 18, v113
    v_lshl_add_u32 v121, v121, 2, s72
    v_and_b32 v125, 0x3c0, v125
    v_and_b32 v64, 28, v121
    v_lshlrev_b32 v57, 9, v64
    ds_read_b32 v121, v121 offset:1280
    v_add_u32 v64, s72, v64
    ds_read_b32 v64, v64 offset:1836
    v_and_b32 v57, s74, v57
    v_lshrrev_b32 v122, 25, v114
    v_lshrrev_b32 v126, 18, v114
    v_lshl_add_u32 v122, v122, 2, s72
    v_and_b32 v126, 0x3c0, v126
    v_and_b32 v68, 28, v122
    v_lshlrev_b32 v58, 9, v68
    ds_read_b32 v122, v122 offset:1280
    v_add_u32 v68, s72, v68
    ds_read_b32 v68, v68 offset:1836
    v_and_b32 v58, s74, v58
    v_mov_b32 v53, v9
    v_mov_b32 v55, v9
    v_mov_b32 v76, 0x3f80
    s_cmp_lg_u32 s55, 0
    s_cbranch_scc1 K2_NOGEO
    s_sub_u32 s56, s11, s54
    s_cmp_le_u32 s56, 48
    s_cselect_b32 s60, 1, 0
    s_mul_i32 s57, s56, 190
    s_add_u32 s57, s57, 255
    s_lshr_b32 s57, s57, 8
    s_cmp_eq_u32 s60, 1
    s_cselect_b32 s57, s57, 48
    s_cselect_b32 s56, s56, 48
    s_add_u32 s79, s54, s57
    s_sub_u32 s56, s56, s57
    s_cmp_eq_u32 s5, 0
    s_cselect_b32 s13, s57, s56
    s_cselect_b32 s14, s54, s79
    s_cselect_b32 s83, 0, s57
    s_lshl_b32 s56, s83, 9
    s_lshl_b32 s57, s83, 11
    v_add_u32 v6, s56, v6
    v_add_u32 v5, s56, v5
    v_add_u32 v4, s57, v4
    v_add_u32 v7, s57, v7
K2_NOGEO:
    s_mul_i32 s56, s54, -512
    s_movk_i32 s57, 1024
    s_waitcnt vmcnt(0) lgkmcnt(0)
    v_add3_u32 v116, v116, v120, v60
    v_add_u32 v116, s56, v116
    v_min_u32 v116, 24576, v116
    v_lshl_add_u32 v120, v116, 2, v56
    v_bfe_u32 v112, v116, 4, 3
    v_and_b32 v120, 0xfffffe00, v120
    v_lshl_or_b32 v120, v112, 1, v120
    v_cmp_gt_u32 s[24:25], s57, v116
    v_add3_u32 v117, v117, v121, v64
    v_add_u32 v117, s56, v117
    v_min_u32 v117, 24576, v117
    v_lshl_add_u32 v121, v117, 2, v57
    v_bfe_u32 v113, v117, 4, 3
    v_and_b32 v121, 0xfffffe00, v121
    v_lshl_or_b32 v121, v113, 1, v121
    v_cmp_gt_u32 s[0:1], s57, v117
    v_add3_u32 v118, v118, v122, v68
    v_add_u32 v118, s56, v118
    v_min_u32 v118, 24576, v118
    v_lshl_add_u32 v122, v118, 2, v58
    v_bfe_u32 v114, v118, 4, 3
    v_and_b32 v122, 0xfffffe00, v122
    v_lshl_or_b32 v122, v114, 1, v122
    v_cmp_gt_u32 vcc, s57, v118
    s_branch K2_JAD
K2_GCONT:
    s_cmp_lg_u32 s54, 0
    s_cbranch_scc1 K2_NOINIT
    s_waitcnt vmcnt(6)
K2_NOINIT:
    v_mov_b64 v[64:65], 0
    v_mov_b64 v[66:67], 0
    v_mov_b64 v[68:69], 0
    v_mov_b64 v[70:71], 0
    v_mov_b64 v[72:73], 0
    v_mov_b64 v[74:75], 0
    v_mov_b64 v[76:77], 0
    v_mov_b64 v[78:79], 0
    s_mov_b64 s[22:23], 0
    s_mov_b64 s[52:53], 0
    s_mov_b32 s62, s5
    s_mov_b32 s61, 0
    s_max_u32 s56, s10, s14
    s_cmp_gt_u32 s11, s56
    s_cselect_b32 s57, 8, 0
    s_cselect_b32 s58, 8, 0
    s_lshl_b64 s[52:53], s[52:53], s57
    s_or_b32 s52, s52, s58
    s_sub_u32 s56, s56, s14
    s_min_u32 s56, s56, 62
    s_bitset1_b64 s[22:23], s56
    s_cmp_eq_u32 s79, s11
    s_cselect_b32 s62, 2, s62
    s_cmp_ge_u32 s10, s79
    s_addc_u32 s61, s61, s61
    s_max_u32 s56, s9, s14
    s_cmp_gt_u32 s10, s56
    s_cselect_b32 s57, 8, 0
    s_cselect_b32 s58, 6, 0
    s_lshl_b64 s[52:53], s[52:53], s57
    s_or_b32 s52, s52, s58
    s_sub_u32 s56, s56, s14
    s_min_u32 s56, s56, 62
    s_bitset1_b64 s[22:23], s56
    s_cmp_eq_u32 s79, s10
    s_cselect_b32 s62, 2, s62
    s_cmp_ge_u32 s9, s79
    s_addc_u32 s61, s61, s61
    s_max_u32 s56, s8, s14
    s_cmp_gt_u32 s9, s56
    s_cselect_b32 s57, 8, 0
    s_cselect_b32 s58, 4, 0
    s_lshl_b64 s[52:53], s[52:53], s57
    s_or_b32 s52, s52, s58
    s_sub_u32 s56, s56, s14
    s_min_u32 s56, s56, 62
    s_bitset1_b64 s[22:23], s56
    s_cmp_eq_u32 s79, s9
    s_cselect_b32 s62, 2, s62
    s_cmp_ge_u32 s8, s79
    s_addc_u32 s61, s61, s61
    s_max_u32 s56, s7, s14
    s_cmp_gt_u32 s8, s56
    s_cselect_b32 s57, 8, 0
    s_cselect_b32 s58, 2, 0
    s_lshl_b64 s[52:53], s[52:53], s57
    s_or_b32 s52, s52, s58
    s_sub_u32 s56, s56, s14
    s_min_u32 s56, s56, 62
    s_bitset1_b64 s[22:23], s56
    s_cmp_eq_u32 s79, s8
    s_cselect_b32 s62, 2, s62
    s_cmp_ge_u32 s7, s79
    s_addc_u32 s61, s61, s61
    s_max_u32 s56, s6, s14
    s_cmp_gt_u32 s7, s56
    s_cselect_b32 s57, 8, 0
    s_cselect_b32 s58, 0, 0
    s_lshl_b64 s[52:53], s[52:53], s57
    s_or_b32 s52, s52, s58
    s_cmp_eq_u32 s79, s7
    s_cselect_b32 s62, 2, s62
    s_cmp_ge_u32 s6, s79
    s_addc_u32 s61, s61, s61
    s_lshr_b64 s[48:49], s[22:23], 1
    s_lshl_b64 s[22:23], s[48:49], 2
    s_lshl_b64 s[50:51], s[52:53], 2
    s_or_b64 s[20:21], s[48:49], s[22:23]
    s_sub_u32 s56, s13, 1
    s_bfm_b64 s[24:25], s56, 0
    s_and_b64 s[20:21], s[20:21], s[24:25]
    s_bitset1_b64 s[20:21], s56
    s_ff1_i32_b64 s15, s[20:21]
    s_mov_b32 s12, s15
    s_mov_b64 vcc, 0
    v_bfe_u32 v230, v1, 7, 1
    v_lshrrev_b32 v230, v230, s61
    v_bfe_u32 v18, v230, 0, 1
    v_lshl_add_u32 v18, v18, 14, v13
    v_bfe_u32 v19, v230, 2, 1
    v_lshl_add_u32 v19, v19, 14, v13
    v_bfe_u32 v20, v230, 4, 1
    v_lshl_add_u32 v20, v20, 14, v13
    s_set_gpr_idx_on s52, gpr_idx(SRC0)
    v_mov_b32 v38, v42
    v_mov_b32 v39, v43
    s_set_gpr_idx_off
    s_mov_b32 m0, s59
    s_lshr_b64 s[52:53], s[52:53], 8
    s_waitcnt lgkmcnt(0)
    s_barrier
    ds_read_u16 v8, v6 offset:0
    ds_read_u16 v10, v6 offset:256
    ds_read_u16 v52, v6 offset:512
    ds_read_u16 v54, v6 offset:768
    ds_read_b64_tr_b16 v[60:61], v4 offset:0
    ds_read_b64 v[62:63], v5 offset:0
    s_waitcnt lgkmcnt(4)
    buffer_load_dwordx4 v[8:9], s[40:43], s44 idxen offen offset:0 lds
    buffer_load_dwordx4 v[10:11], s[40:43], s45 idxen offen offset:1024 lds
    s_waitcnt lgkmcnt(2)
    buffer_load_dwordx4 v[52:53], s[40:43], s46 idxen offen offset:2048 lds
    buffer_load_dwordx4 v[54:55], s[40:43], s47 idxen offen offset:3072 lds
    ds_read_u16 v8, v6 offset:1024
    ds_read_u16 v10, v6 offset:1280
    s_cmp_lg_u32 s13, 0
    s_cbranch_scc1 K2_JOIN
    s_waitcnt lgkmcnt(0)
    s_cmp_eq_u32 s60, 0
    s_cbranch_scc1 K2_NEXTROUND
    buffer_load_dwordx4 v[240:243], v1, s[36:39], s67 offen offset:0
    buffer_load_dwordx4 v[244:247], v1, s[36:39], s67 offen offset:1024
    buffer_load_dwordx4 v[248:251], v1, s[36:39], s67 offen offset:2048
    buffer_load_dwordx4 v[252:255], v1, s[36:39], s67 offen offset:3072
    s_waitcnt vmcnt(0)
    s_sub_u32 s58, s5, 1
    s_xor_b32 s58, s58, s61
    s_lshr_b32 s57, s50, 3
    s_bitset0_b32 s58, s57
    s_lshl2_add_u32 s62, s60, s62
    s_movk_i32 s24, 0xff
    s_movk_i32 s25, 0xff
    v_mfma_f32_16x16x32_bf16 v[96:99], v[200:203], v[160:163], 0
    v_mfma_f32_16x16x32_bf16 v[100:103], v[200:203], v[168:171], 0
    v_mfma_f32_16x16x32_bf16 v[104:107], v[200:203], v[176:179], 0
    v_mfma_f32_16x16x32_bf16 v[108:111], v[200:203], v[184:187], 0
    v_mfma_f32_16x16x32_bf16 v[112:115], v[200:203], v[192:195], 0
    v_mfma_f32_16x16x32_bf16 v[96:99], v[204:207], v[164:167], v[96:99]
    v_mfma_f32_16x16x32_bf16 v[100:103], v[204:207], v[172:175], v[100:103]
    v_mfma_f32_16x16x32_bf16 v[104:107], v[204:207], v[180:183], v[104:107]
    v_mfma_f32_16x16x32_bf16 v[108:111], v[204:207], v[188:191], v[108:111]
    v_mfma_f32_16x16x32_bf16 v[112:115], v[204:207], v[196:199], v[112:115]
    s_nop 7
    v_mov_b32 v52, v96
    v_mov_b32 v53, v100
    v_mov_b32 v54, v104
    v_mov_b32 v55, v108
    v_mov_b32 v56, v112
    s_branch K2_FIN
K2_ENDROUND:
    s_add_u32 s56, s13, 1
    s_bitcmp1_b64 s[22:23], s56
    s_cbranch_scc0 K2_NEXTROUND
    s_nop 7
    s_call_b64 s[30:31], K2_FLUSH
K2_NEXTROUND:
    s_add_u32 s54, s54, 48
    s_lshl_b32 s56, s83, 9
    s_lshl_b32 s57, s83, 11
    v_subrev_u32 v6, s56, v6
    v_subrev_u32 v5, s56, v5
    v_subrev_u32 v4, s57, v4
    v_subrev_u32 v7, s57, v7
    s_waitcnt vmcnt(0) lgkmcnt(0)
    s_barrier
    v_mov_b64 v[152:153], 0
    v_mov_b64 v[154:155], 0
    v_lshlrev_b32 v156, 4, v0
    ds_write_b128 v156, v[152:155] offset:37888
    ds_write_b128 v156, v[152:155] offset:46080
    ds_write_b128 v156, v[152:155] offset:54272
    ds_write_b128 v156, v[152:155] offset:62720
    v_add_u32 v156, 70912, v156
    ds_write_b128 v156, v[152:155] offset:0
    ds_write_b128 v156, v[152:155] offset:8192
    ds_write_b128 v156, v[152:155] offset:16384
    ds_write_b128 v156, v[152:155] offset:24576
    ds_write_b128 v156, v[152:155] offset:32768
    ds_write_b128 v156, v[152:155] offset:40960
    ds_write_b128 v156, v[152:155] offset:49152
    ds_write_b128 v156, v[152:155] offset:57344
    v_add_u32 v156, 65536, v156
    ds_write_b128 v156, v[152:155] offset:0
    ds_write_b128 v156, v[152:155] offset:8192
    ds_write_b128 v156, v[152:155] offset:16384
    s_waitcnt lgkmcnt(0)
    s_barrier
    s_sub_u32 s56, 0, s55
    s_branch K2_SHIFT
.p2align 7
.type K2_TAB,@object
K2_TAB:
.long 0x3f80, 0x0, 0x0, 0x0
.long 0x3f80, 0x8, 0x10, 0x6
.long 0x3f80, 0x10, 0x20, 0xc
.long 0x3f80, 0x18, 0x30, 0x12
.long 0x3f80, 0x140, 0x40, 0x18
.long 0x3f80, 0x148, 0x50, 0x1e
.long 0x3f80, 0x150, 0x60, 0x24
.long 0x3f80, 0x158, 0x70, 0x2a
.long 0x3f80, 0x280, 0x4, 0x2
.long 0x3f80, 0x288, 0x14, 0x8
.long 0x3f80, 0x290, 0x24, 0xe
.long 0x3f80, 0x298, 0x34, 0x14
.long 0x3f80, 0x3c0, 0x44, 0x1a
.long 0x3f80, 0x3c8, 0x54, 0x20
.long 0x3f80, 0x3d0, 0x64, 0x26
.long 0x3f80, 0x3d8, 0x74, 0x2c
.long 0x3f80, 0x800, 0x8, 0x4
.long 0x3f80, 0x808, 0x18, 0xa
.long 0x3f80, 0x810, 0x28, 0x10
.long 0x3f80, 0x818, 0x38, 0x16
.long 0x3f80, 0x940, 0x48, 0x1c
.long 0x3f80, 0x948, 0x58, 0x22
.long 0x3f80, 0x950, 0x68, 0x28
.long 0x3f80, 0x958, 0x78, 0x2e
.long 0x3f80, 0xa80, 0xc, 0x4
.long 0x3f80, 0xa88, 0x1c, 0xa
.long 0x3f80, 0xa90, 0x2c, 0x10
.long 0x3f80, 0xa98, 0x3c, 0x16
.long 0x3f80, 0xbc0, 0x4c, 0x1c
.long 0x3f80, 0xbc8, 0x5c, 0x22
.long 0x3f80, 0xbd0, 0x6c, 0x28
.long 0x3f80, 0xbd8, 0x7c, 0x2e
.long 0x0, 0x1000, 0xc, 0x4
.long 0x0, 0x1008, 0x1c, 0xa
.long 0x0, 0x1010, 0x2c, 0x10
.long 0x0, 0x1018, 0x3c, 0x16
.long 0x0, 0x1140, 0x4c, 0x1c
.long 0x0, 0x1148, 0x5c, 0x22
.long 0x0, 0x1150, 0x6c, 0x28
.long 0x0, 0x1158, 0x7c, 0x2e
.long 0x0, 0x1280, 0xc, 0x4
.long 0x0, 0x1288, 0x1c, 0xa
.long 0x0, 0x1290, 0x2c, 0x10
.long 0x0, 0x1298, 0x3c, 0x16
.long 0x0, 0x13c0, 0x4c, 0x1c
.long 0x0, 0x13c8, 0x5c, 0x22
.long 0x0, 0x13d0, 0x6c, 0x28
.long 0x0, 0x13d8, 0x7c, 0x2e
.long 0x0, 0x1800, 0xc, 0x4
.long 0x0, 0x1808, 0x1c, 0xa
.long 0x0, 0x1810, 0x2c, 0x10
.long 0x0, 0x1818, 0x3c, 0x16
.long 0x0, 0x1940, 0x4c, 0x1c
.long 0x0, 0x1948, 0x5c, 0x22
.long 0x0, 0x1950, 0x6c, 0x28
.long 0x0, 0x1958, 0x7c, 0x2e
.long 0x0, 0x1a80, 0xc, 0x4
.long 0x0, 0x1a88, 0x1c, 0xa
.long 0x0, 0x1a90, 0x2c, 0x10
.long 0x0, 0x1a98, 0x3c, 0x16
.long 0x0, 0x1bc0, 0x4c, 0x1c
.long 0x0, 0x1bc8, 0x5c, 0x22
.long 0x0, 0x1bd0, 0x6c, 0x28
.long 0x0, 0x1bd8, 0x7c, 0x2e
.long 0x0, 0x8000000, 0x0, 0x500
.long 0x2000000, 0x9000000, 0x10, 0x504
.long 0x4000000, 0x8000000, 0x0, 0x508
.long 0x6000000, 0x9000000, 0x10, 0x50c
.long 0x10000000, 0x18000000, 0x0, 0x520
.long 0x12000000, 0x19000000, 0x10, 0x524
.long 0x14000000, 0x18000000, 0x0, 0x528
.long 0x16000000, 0x19000000, 0x10, 0x52c
.long 0x20000000, 0x28000000, 0x0, 0x540
.long 0x22000000, 0x29000000, 0x10, 0x544
.long 0x24000000, 0x28000000, 0x0, 0x548
.long 0x26000000, 0x29000000, 0x10, 0x54c
.long 0x30000000, 0x38000000, 0x0, 0x560
.long 0x32000000, 0x39000000, 0x10, 0x564
.long 0x34000000, 0x38000000, 0x0, 0x568
.long 0x36000000, 0x39000000, 0x10, 0x56c
.long 0x40000000, 0x48000000, 0x0, 0x580
.long 0x42000000, 0x49000000, 0x10, 0x584
.long 0x44000000, 0x48000000, 0x0, 0x588
.long 0x46000000, 0x49000000, 0x10, 0x58c
.long 0x50000000, 0x58000000, 0x0, 0x5a0
.long 0x52000000, 0x59000000, 0x10, 0x5a4
.long 0x54000000, 0x58000000, 0x0, 0x5a8
.long 0x56000000, 0x59000000, 0x10, 0x5ac
.long 0x60000000, 0x68000000, 0x0, 0x5c0
.long 0x62000000, 0x69000000, 0x10, 0x5c4
.long 0x64000000, 0x68000000, 0x0, 0x5c8
.long 0x66000000, 0x69000000, 0x10, 0x5cc
.long 0x70000000, 0x78000000, 0x0, 0x5e0
.long 0x72000000, 0x79000000, 0x10, 0x5e4
.long 0x74000000, 0x78000000, 0x0, 0x5e8
.long 0x76000000, 0x79000000, 0x10, 0x5ec
.long 0x80000000, 0x88000000, 0x0, 0x600
.long 0x82000000, 0x89000000, 0x10, 0x604
.long 0x84000000, 0x88000000, 0x0, 0x608
.long 0x86000000, 0x89000000, 0x10, 0x60c
.long 0x90000000, 0x98000000, 0x0, 0x620
.long 0x92000000, 0x99000000, 0x10, 0x624
.long 0x94000000, 0x98000000, 0x0, 0x628
.long 0x96000000, 0x99000000, 0x10, 0x62c
.long 0xa0000000, 0xa8000000, 0x0, 0x640
.long 0xa2000000, 0xa9000000, 0x10, 0x644
.long 0xa4000000, 0xa8000000, 0x0, 0x648
.long 0xa6000000, 0xa9000000, 0x10, 0x64c
.long 0xb0000000, 0xb8000000, 0x0, 0x660
.long 0xb2000000, 0xb9000000, 0x10, 0x664
.long 0xb4000000, 0xb8000000, 0x0, 0x668
.long 0xb6000000, 0xb9000000, 0x10, 0x66c
.long 0xc0000000, 0xc8000000, 0x0, 0x680
.long 0xc2000000, 0xc9000000, 0x10, 0x684
.long 0xc4000000, 0xc8000000, 0x0, 0x688
.long 0xc6000000, 0xc9000000, 0x10, 0x68c
.long 0xd0000000, 0xd8000000, 0x0, 0x6a0
.long 0xd2000000, 0xd9000000, 0x10, 0x6a4
.long 0xd4000000, 0xd8000000, 0x0, 0x6a8
.long 0xd6000000, 0xd9000000, 0x10, 0x6ac
.long 0xe0000000, 0xe8000000, 0x0, 0x6c0
.long 0xe2000000, 0xe9000000, 0x10, 0x6c4
.long 0xe4000000, 0xe8000000, 0x0, 0x6c8
.long 0xe6000000, 0xe9000000, 0x10, 0x6cc
.long 0xf0000000, 0xf8000000, 0x0, 0x6e0
.long 0xf2000000, 0xf9000000, 0x10, 0x6e4
.long 0xf4000000, 0xf8000000, 0x0, 0x6e8
.long 0xf6000000, 0xf9000000, 0x10, 0x6ec
.long 0x940a, 0xed00, 0xc00, 0x0
.long 0x940a, 0xed10, 0xc04, 0x10
.long 0x940a, 0xed20, 0xc08, 0x20
.long 0x940a, 0xed30, 0xc0c, 0x30
.long 0x941a, 0xed40, 0xc10, 0x0
.long 0x941a, 0xed50, 0xc14, 0x10
.long 0x941a, 0xed60, 0xc18, 0x20
.long 0x941a, 0xed70, 0xc1c, 0x30
.long 0x942a, 0xed80, 0xc20, 0x0
.long 0x942a, 0xed90, 0xc24, 0x10
.long 0x942a, 0xeda0, 0xc28, 0x20
.long 0x942a, 0xedb0, 0xc2c, 0x30
.long 0x943a, 0xedc0, 0xc30, 0x0
.long 0x943a, 0xedd0, 0xc34, 0x10
.long 0x943a, 0xede0, 0xc38, 0x20
.long 0x943a, 0xedf0, 0xc3c, 0x30
.long 0x948a, 0xee00, 0xc40, 0x10
.long 0x948a, 0xee10, 0xc44, 0x0
.long 0x948a, 0xee20, 0xc48, 0x30
.long 0x948a, 0xee30, 0xc4c, 0x20
.long 0x949a, 0xee40, 0xc50, 0x10
.long 0x949a, 0xee50, 0xc54, 0x0
.long 0x949a, 0xee60, 0xc58, 0x30
.long 0x949a, 0xee70, 0xc5c, 0x20
.long 0x94aa, 0xee80, 0xc60, 0x10
.long 0x94aa, 0xee90, 0xc64, 0x0
.long 0x94aa, 0xeea0, 0xc68, 0x30
.long 0x94aa, 0xeeb0, 0xc6c, 0x20
.long 0x94ba, 0xeec0, 0xc70, 0x10
.long 0x94ba, 0xeed0, 0xc74, 0x0
.long 0x94ba, 0xeee0, 0xc78, 0x30
.long 0x94ba, 0xeef0, 0xc7c, 0x20
.long 0x944a, 0xef00, 0xc80, 0x20
.long 0x944a, 0xef10, 0xc84, 0x30
.long 0x944a, 0xef20, 0xc88, 0x0
.long 0x944a, 0xef30, 0xc8c, 0x10
.long 0x945a, 0xef40, 0xc90, 0x20
.long 0x945a, 0xef50, 0xc94, 0x30
.long 0x945a, 0xef60, 0xc98, 0x0
.long 0x945a, 0xef70, 0xc9c, 0x10
.long 0x946a, 0xef80, 0xca0, 0x20
.long 0x946a, 0xef90, 0xca4, 0x30
.long 0x946a, 0xefa0, 0xca8, 0x0
.long 0x946a, 0xefb0, 0xcac, 0x10
.long 0x947a, 0xefc0, 0xcb0, 0x20
.long 0x947a, 0xefd0, 0xcb4, 0x30
.long 0x947a, 0xefe0, 0xcb8, 0x0
.long 0x947a, 0xeff0, 0xcbc, 0x10
.long 0x94ca, 0xf000, 0xcc0, 0x30
.long 0x94ca, 0xf010, 0xcc4, 0x20
.long 0x94ca, 0xf020, 0xcc8, 0x10
.long 0x94ca, 0xf030, 0xccc, 0x0
.long 0x94da, 0xf040, 0xcd0, 0x30
.long 0x94da, 0xf050, 0xcd4, 0x20
.long 0x94da, 0xf060, 0xcd8, 0x10
.long 0x94da, 0xf070, 0xcdc, 0x0
.long 0x94ea, 0xf080, 0xce0, 0x30
.long 0x94ea, 0xf090, 0xce4, 0x20
.long 0x94ea, 0xf0a0, 0xce8, 0x10
.long 0x94ea, 0xf0b0, 0xcec, 0x0
.long 0x94fa, 0xf0c0, 0xcf0, 0x30
.long 0x94fa, 0xf0d0, 0xcf4, 0x20
.long 0x94fa, 0xf0e0, 0xcf8, 0x10
.long 0x94fa, 0xf0f0, 0xcfc, 0x0
.long 0x0, 0x0, 0xf500, 0x9400
.long 0x40, 0x40, 0xf700, 0x9410
.long 0x80, 0x90, 0xf508, 0x9420
.long 0xc0, 0xd0, 0xf708, 0x9430
.long 0x110, 0x120, 0xf510, 0x9480
.long 0x150, 0x160, 0xf710, 0x9490
.long 0x190, 0x1b0, 0xf518, 0x94a0
.long 0x1d0, 0x1f0, 0xf718, 0x94b0
.long 0x220, 0x200, 0xf520, 0x9440
.long 0x260, 0x240, 0xf720, 0x9450
.long 0x2a0, 0x290, 0xf528, 0x9460
.long 0x2e0, 0x2d0, 0xf728, 0x9470
.long 0x330, 0x320, 0xf530, 0x94c0
.long 0x370, 0x360, 0xf730, 0x94d0
.long 0x3b0, 0x3b0, 0xf538, 0x94e0
.long 0x3f0, 0x3f0, 0xf738, 0x94f0
.long 0x400, 0x0, 0xf900, 0x9500
.long 0x440, 0x40, 0xfb00, 0x9510
.long 0x480, 0x90, 0xf908, 0x9520
.long 0x4c0, 0xd0, 0xfb08, 0x9530
.long 0x510, 0x120, 0xf910, 0x9580
.long 0x550, 0x160, 0xfb10, 0x9590
.long 0x590, 0x1b0, 0xf918, 0x95a0
.long 0x5d0, 0x1f0, 0xfb18, 0x95b0
.long 0x620, 0x200, 0xf920, 0x9540
.long 0x660, 0x240, 0xfb20, 0x9550
.long 0x6a0, 0x290, 0xf928, 0x9560
.long 0x6e0, 0x2d0, 0xfb28, 0x9570
.long 0x730, 0x320, 0xf930, 0x95c0
.long 0x770, 0x360, 0xfb30, 0x95d0
.long 0x7b0, 0x3b0, 0xf938, 0x95e0
.long 0x7f0, 0x3f0, 0xfb38, 0x95f0
.long 0x10, 0x20, 0xf540, 0x9408
.long 0x50, 0x60, 0xf740, 0x9418
.long 0x90, 0xb0, 0xf548, 0x9428
.long 0xd0, 0xf0, 0xf748, 0x9438
.long 0x100, 0x100, 0xf550, 0x9488
.long 0x140, 0x140, 0xf750, 0x9498
.long 0x180, 0x190, 0xf558, 0x94a8
.long 0x1c0, 0x1d0, 0xf758, 0x94b8
.long 0x230, 0x220, 0xf560, 0x9448
.long 0x270, 0x260, 0xf760, 0x9458
.long 0x2b0, 0x2b0, 0xf568, 0x9468
.long 0x2f0, 0x2f0, 0xf768, 0x9478
.long 0x320, 0x300, 0xf570, 0x94c8
.long 0x360, 0x340, 0xf770, 0x94d8
.long 0x3a0, 0x390, 0xf578, 0x94e8
.long 0x3e0, 0x3d0, 0xf778, 0x94f8
.long 0x410, 0x20, 0xf940, 0x9508
.long 0x450, 0x60, 0xfb40, 0x9518
.long 0x490, 0xb0, 0xf948, 0x9528
.long 0x4d0, 0xf0, 0xfb48, 0x9538
.long 0x500, 0x100, 0xf950, 0x9588
.long 0x540, 0x140, 0xfb50, 0x9598
.long 0x580, 0x190, 0xf958, 0x95a8
.long 0x5c0, 0x1d0, 0xfb58, 0x95b8
.long 0x630, 0x220, 0xf960, 0x9548
.long 0x670, 0x260, 0xfb60, 0x9558
.long 0x6b0, 0x2b0, 0xf968, 0x9568
.long 0x6f0, 0x2f0, 0xfb68, 0x9578
.long 0x720, 0x300, 0xf970, 0x95c8
.long 0x760, 0x340, 0xfb70, 0x95d8
.long 0x7a0, 0x390, 0xf978, 0x95e8
.long 0x7e0, 0x3d0, 0xfb78, 0x95f8
.long 0x0, 0x0, 0x0, 0x0
.long 0x110, 0x10, 0x100, 0x40
.long 0x220, 0x20, 0x200, 0x90
.long 0x330, 0x30, 0x300, 0xd0
.long 0x440, 0x0, 0x400, 0x120
.long 0x550, 0x10, 0x500, 0x160
.long 0x660, 0x20, 0x600, 0x1b0
.long 0x770, 0x30, 0x700, 0x1f0
.long 0x880, 0x0, 0x800, 0x200
.long 0x990, 0x10, 0x900, 0x240
.long 0xaa0, 0x20, 0xa00, 0x290
.long 0xbb0, 0x30, 0xb00, 0x2d0
.long 0xcc0, 0x0, 0xc00, 0x320
.long 0xdd0, 0x10, 0xd00, 0x360
.long 0xee0, 0x20, 0xe00, 0x3b0
.long 0xff0, 0x30, 0xf00, 0x3f0
.long 0x8, 0x10, 0x8, 0x10
.long 0x118, 0x0, 0x108, 0x50
.long 0x228, 0x30, 0x208, 0x80
.long 0x338, 0x20, 0x308, 0xc0
.long 0x448, 0x10, 0x408, 0x130
.long 0x558, 0x0, 0x508, 0x170
.long 0x668, 0x30, 0x608, 0x1a0
.long 0x778, 0x20, 0x708, 0x1e0
.long 0x888, 0x10, 0x808, 0x210
.long 0x998, 0x0, 0x908, 0x250
.long 0xaa8, 0x30, 0xa08, 0x280
.long 0xbb8, 0x20, 0xb08, 0x2c0
.long 0xcc8, 0x10, 0xc08, 0x330
.long 0xdd8, 0x0, 0xd08, 0x370
.long 0xee8, 0x30, 0xe08, 0x3a0
.long 0xff8, 0x20, 0xf08, 0x3e0
.long 0x10, 0x20, 0x10, 0x20
.long 0x100, 0x30, 0x110, 0x60
.long 0x230, 0x0, 0x210, 0xb0
.long 0x320, 0x10, 0x310, 0xf0
.long 0x450, 0x20, 0x410, 0x100
.long 0x540, 0x30, 0x510, 0x140
.long 0x670, 0x0, 0x610, 0x190
.long 0x760, 0x10, 0x710, 0x1d0
.long 0x890, 0x20, 0x810, 0x220
.long 0x980, 0x30, 0x910, 0x260
.long 0xab0, 0x0, 0xa10, 0x2b0
.long 0xba0, 0x10, 0xb10, 0x2f0
.long 0xcd0, 0x20, 0xc10, 0x300
.long 0xdc0, 0x30, 0xd10, 0x340
.long 0xef0, 0x0, 0xe10, 0x390
.long 0xfe0, 0x10, 0xf10, 0x3d0
.long 0x18, 0x30, 0x18, 0x30
.long 0x108, 0x20, 0x118, 0x70
.long 0x238, 0x10, 0x218, 0xa0
.long 0x328, 0x0, 0x318, 0xe0
.long 0x458, 0x30, 0x418, 0x110
.long 0x548, 0x20, 0x518, 0x150
.long 0x678, 0x10, 0x618, 0x180
.long 0x768, 0x0, 0x718, 0x1c0
.long 0x898, 0x30, 0x818, 0x230
.long 0x988, 0x20, 0x918, 0x270
.long 0xab8, 0x10, 0xa18, 0x2a0
.long 0xba8, 0x0, 0xb18, 0x2e0
.long 0xcd8, 0x30, 0xc18, 0x310
.long 0xdc8, 0x20, 0xd18, 0x350
.long 0xef8, 0x10, 0xe18, 0x380
.long 0xfe8, 0x0, 0xf18, 0x3c0
.long 0x0, 0x40, 0x80, 0xc0
.long 0x110, 0x150, 0x190, 0x1d0
.long 0x220, 0x260, 0x2a0, 0x2e0
.long 0x330, 0x370, 0x3b0, 0x3f0
.long 0x440, 0x400, 0x4c0, 0x480
.long 0x550, 0x510, 0x5d0, 0x590
.long 0x660, 0x620, 0x6e0, 0x6a0
.long 0x770, 0x730, 0x7f0, 0x7b0
.long 0x880, 0x8c0, 0x800, 0x840
.long 0x990, 0x9d0, 0x910, 0x950
.long 0xaa0, 0xae0, 0xa20, 0xa60
.long 0xbb0, 0xbf0, 0xb30, 0xb70
.long 0xcc0, 0xc80, 0xc40, 0xc00
.long 0xdd0, 0xd90, 0xd50, 0xd10
.long 0xee0, 0xea0, 0xe60, 0xe20
.long 0xff0, 0xfb0, 0xf70, 0xf30
.long 0x10, 0x50, 0x90, 0xd0
.long 0x100, 0x140, 0x180, 0x1c0
.long 0x230, 0x270, 0x2b0, 0x2f0
.long 0x320, 0x360, 0x3a0, 0x3e0
.long 0x450, 0x410, 0x4d0, 0x490
.long 0x540, 0x500, 0x5c0, 0x580
.long 0x670, 0x630, 0x6f0, 0x6b0
.long 0x760, 0x720, 0x7e0, 0x7a0
.long 0x890, 0x8d0, 0x810, 0x850
.long 0x980, 0x9c0, 0x900, 0x940
.long 0xab0, 0xaf0, 0xa30, 0xa70
.long 0xba0, 0xbe0, 0xb20, 0xb60
.long 0xcd0, 0xc90, 0xc50, 0xc10
.long 0xdc0, 0xd80, 0xd40, 0xd00
.long 0xef0, 0xeb0, 0xe70, 0xe30
.long 0xfe0, 0xfa0, 0xf60, 0xf20
.long 0x20, 0x60, 0xa0, 0xe0
.long 0x130, 0x170, 0x1b0, 0x1f0
.long 0x200, 0x240, 0x280, 0x2c0
.long 0x310, 0x350, 0x390, 0x3d0
.long 0x460, 0x420, 0x4e0, 0x4a0
.long 0x570, 0x530, 0x5f0, 0x5b0
.long 0x640, 0x600, 0x6c0, 0x680
.long 0x750, 0x710, 0x7d0, 0x790
.long 0x8a0, 0x8e0, 0x820, 0x860
.long 0x9b0, 0x9f0, 0x930, 0x970
.long 0xa80, 0xac0, 0xa00, 0xa40
.long 0xb90, 0xbd0, 0xb10, 0xb50
.long 0xce0, 0xca0, 0xc60, 0xc20
.long 0xdf0, 0xdb0, 0xd70, 0xd30
.long 0xec0, 0xe80, 0xe40, 0xe00
.long 0xfd0, 0xf90, 0xf50, 0xf10
.long 0x30, 0x70, 0xb0, 0xf0
.long 0x120, 0x160, 0x1a0, 0x1e0
.long 0x210, 0x250, 0x290, 0x2d0
.long 0x300, 0x340, 0x380, 0x3c0
.long 0x470, 0x430, 0x4f0, 0x4b0
.long 0x560, 0x520, 0x5e0, 0x5a0
.long 0x650, 0x610, 0x6d0, 0x690
.long 0x740, 0x700, 0x7c0, 0x780
.long 0x8b0, 0x8f0, 0x830, 0x870
.long 0x9a0, 0x9e0, 0x920, 0x960
.long 0xa90, 0xad0, 0xa10, 0xa50
.long 0xb80, 0xbc0, 0xb00, 0xb40
.long 0xcf0, 0xcb0, 0xc70, 0xc30
.long 0xde0, 0xda0, 0xd60, 0xd20
.long 0xed0, 0xe90, 0xe50, 0xe10
.long 0xfc0, 0xf80, 0xf40, 0xf00
.long 0x580000, 0x57fc00, 0x57f800, 0x57f400, 0x0, 0x0, 0x18100800, 0x0, 0x60402, 0x0, 0x0, 0x0, 0x0, 0x0, 0x2000, 0x0
.long 0x580040, 0x57fc40, 0x57f840, 0x57f440, 0x0, 0x0, 0x18100800, 0x0, 0x60402, 0x0, 0x0, 0x0, 0x40, 0x10, 0x2100, 0x1000
.long 0x580080, 0x57fc80, 0x57f880, 0x57f480, 0x0, 0x0, 0x18100800, 0x0, 0x60402, 0x0, 0x0, 0x0, 0x80, 0x20, 0x2200, 0x2000
.long 0x5800c0, 0x57fcc0, 0x57f8c0, 0x57f4c0, 0x0, 0x0, 0x18100800, 0x0, 0x60402, 0x0, 0x0, 0x0, 0xc0, 0x30, 0x2300, 0x3000
.long 0x580000, 0x57fc00, 0x57f800, 0x57f400, 0x0, 0x0, 0x2018, 0x0, 0x8, 0x0, 0x0, 0x0, 0x0, 0x40, 0x2400, 0x4000
.long 0x580040, 0x57fc40, 0x57f840, 0x57f440, 0x0, 0x0, 0x2018, 0x0, 0x8, 0x0, 0x0, 0x0, 0x40, 0x50, 0x2500, 0x5000
.long 0x580080, 0x57fc80, 0x57f880, 0x57f480, 0x0, 0x0, 0x2018, 0x0, 0x8, 0x0, 0x0, 0x0, 0x80, 0x60, 0x2600, 0x6000
.long 0x5800c0, 0x57fcc0, 0x57f8c0, 0x57f4c0, 0x0, 0x0, 0x2018, 0x0, 0x8, 0x0, 0x0, 0x0, 0xc0, 0x70, 0x2700, 0x7000
.long 0x1, 0x10, 0x0, 0x70, 0x3400, 0x3fff0000, 0x6400, 0xa81000, 0x0, 0x0, 0xbf80, 0xbf800000, 0x3000, 0x0, 0x3800, 0x580000
.long 0x1, 0x10, 0x0, 0x70, 0x3c00, 0x3fff0000, 0x6400, 0xa83000, 0x30, 0x20, 0xbf80, 0xbf800000, 0x3800, 0x0, 0x3800, 0x580000
.long 0x1, 0x10, 0x0, 0x70, 0x4400, 0x3fff0000, 0x6400, 0xa85000, 0x60, 0x40, 0xbf80, 0xbf800000, 0x4000, 0x0, 0x3800, 0x580000
.long 0x1, 0x10, 0x0, 0x70, 0x4c00, 0x3fff0000, 0x6400, 0xa87000, 0x90, 0x60, 0xbf80, 0xbf800000, 0x4800, 0x0, 0x3800, 0x580000
.long 0x1, 0x10, 0x1, 0x70, 0x5400, 0x3fff0000, 0x6400, 0xa89000, 0xc0, 0x80, 0xbf80, 0xbf800000, 0x5000, 0x0, 0x3800, 0x580000
.long 0x1, 0x10, 0x1, 0x70, 0x5c00, 0x3fff0000, 0x6400, 0xa8b000, 0xf0, 0xa0, 0xbf80, 0xbf800000, 0x5800, 0x0, 0x3800, 0x580000
.long 0x1, 0x10, 0x1, 0x70, 0x6400, 0x3fff0000, 0x6400, 0xa8d000, 0x120, 0xc0, 0xbf80, 0xbf800000, 0x6000, 0x0, 0x3800, 0x580000
.long 0x1, 0x10, 0x1, 0x70, 0x6c00, 0x3fff0000, 0x6400, 0xa8f000, 0x150, 0xe0, 0xbf80, 0xbf800000, 0x6800, 0x0, 0x3800, 0x580000
.long 0x0, 0x0, 0x20, 0x800000, 0xa90000, 0xc000, 0x2400, 0xa80000, 0x0, 0x0, 0x0, 0x0, 0x0, 0x0, 0x0, 0x0
.long 0x1, 0x0, 0xa0, 0x800200, 0xa90c00, 0xe000, 0x2c00, 0xa82000, 0x0, 0x0, 0x0, 0x0, 0x0, 0x0, 0x0, 0x0
.long 0x2, 0x0, 0x120, 0x800400, 0xa91800, 0x10000, 0x3400, 0xa84000, 0x0, 0x0, 0x0, 0x0, 0x0, 0x0, 0x0, 0x0
.long 0x3, 0x0, 0x1a0, 0x800600, 0xa92400, 0x12000, 0x3c00, 0xa86000, 0x0, 0x0, 0x0, 0x0, 0x0, 0x0, 0x0, 0x0
.long 0x0, 0x1, 0x220, 0x800000, 0xa90000, 0x14000, 0x4400, 0xa88000, 0x0, 0x0, 0x0, 0x0, 0x0, 0x0, 0x0, 0x0
.long 0x1, 0x1, 0x2a0, 0x800200, 0xa90c00, 0x16000, 0x4c00, 0xa8a000, 0x0, 0x0, 0x0, 0x0, 0x0, 0x0, 0x0, 0x0
.long 0x2, 0x1, 0x320, 0x800400, 0xa91800, 0x18000, 0x5400, 0xa8c000, 0x0, 0x0, 0x0, 0x0, 0x0, 0x0, 0x0, 0x0
.long 0x3, 0x1, 0x3a0, 0x800600, 0xa92400, 0x1a000, 0x5c00, 0xa8e000, 0x0, 0x0, 0x0, 0x0, 0x0, 0x0, 0x0, 0x0
.fill 128, 4, 0
.size K2_TAB, 8192
K2_LAST:
.section .rodata,"a"
.p2align 6
.amdhsa_kernel gather_scatter__cheap_equivariant_egnn__graph_kernel
  .amdhsa_next_free_vgpr 256
  .amdhsa_next_free_sgpr 102
  .amdhsa_accum_offset 256
  .amdhsa_group_segment_fixed_size 0
  .amdhsa_kernarg_size 88
  .amdhsa_user_sgpr_count 2
  .amdhsa_user_sgpr_kernarg_segment_ptr 1
  .amdhsa_system_sgpr_workgroup_id_x 1
  .amdhsa_float_denorm_mode_32 3
.end_amdhsa_kernel
```
